```python
import torch

def _softmax(x, axis=-1):
    return torch.softmax(x, dim=axis)
def _gelu(x):
    return torch.nn.functional.gelu(x, approximate="tanh")
def _silu(x):
    return torch.nn.functional.silu(x)
def _sigmoid(x):
    return torch.sigmoid(x)
def _layernorm(x, axis=-1, eps=1e-5):
    m = x.mean(dim=axis, keepdim=True)
    v = x.var(dim=axis, keepdim=True, unbiased=False)
    return (x - m) / torch.sqrt(v + eps)
def _scatter_add(tgt, idx, src, axis=0):
    return tgt.clone().index_add_(axis, idx, src)
def _segment_sum(src, seg, n):
    out = torch.zeros((n,) + src.shape[1:], dtype=src.dtype)
    return out.index_add_(0, seg, src)
def _pad(x, pw):
    flat = tuple(v for pair in reversed(pw) for v in pair)
    return torch.nn.functional.pad(x, flat)

kernel_name = 'standalone__mha_block_cached__near_ridge'

def setup_inputs():

    _w = (lambda a: (lambda t: t.to(torch.bfloat16) if t.is_floating_point() else t)(torch.as_tensor(a)))
    B, Sq, D = 8, 64, 640
    H, Sk, Dh = 32, 64, 192
    return {
        "x": _w((lambda *s: torch.randn(*s, dtype=torch.bfloat16) * 0.8)(B, Sq, D)),
        "k_cache": _w((lambda *s: torch.randn(*s, dtype=torch.bfloat16) * 0.8)(B, H, Sk, Dh)),
        "v_cache": _w((lambda *s: torch.randn(*s, dtype=torch.bfloat16) * 0.05)(B, H, Sk, Dh)),
        "wq": _w((lambda *s: torch.randn(*s, dtype=torch.bfloat16) * 0.8)(D, H * Dh) * (D ** -0.5)),
        "wo": _w((lambda *s: torch.randn(*s, dtype=torch.bfloat16) * 0.05)(H * Dh, D) * ((H * Dh) ** -0.5)),
    }

def reference(x, k_cache, v_cache, wq, wo):
    B, Sq, D = x.shape
    H, Dh = 32, 192
    q = (lambda x, *d: x.permute(*d))((x @ wq).reshape(B, Sq, H, Dh), 0, 2, 1, 3)
    scores = torch.einsum("bhqd,bhkd->bhqk", q, k_cache) * (Dh ** -0.5)
    p = _softmax(scores, axis=-1)
    o = torch.einsum("bhqk,bhkd->bhqd", p, v_cache)
    return (lambda x, *d: x.permute(*d))(o, 0, 2, 1, 3).reshape(B, Sq, H * Dh) @ wo
```

```asm
; @launch grid=(256,1,1) block=(512,1,1) lds=163840
.amdgcn_target "amdgcn-amd-amdhsa--gfx950"
.text
.globl standalone__mha_block_cached__near_ridge_kernel
.p2align 8
.type standalone__mha_block_cached__near_ridge_kernel,@function
standalone__mha_block_cached__near_ridge_kernel:
    s_cmp_ge_u32 s2, 256
    s_cbranch_scc1 L_end
    s_load_dwordx16 s[40:55], s[0:1], 0
    v_lshrrev_b32 v2, 6, v0
    v_and_b32 v1, 63, v0
    v_readfirstlane_b32 s3, v2
    s_and_b32 s5, s2, 7
    s_lshr_b32 s62, s2, 3
    s_and_b32 s6, s62, 3
    s_lshr_b32 s4, s2, 5
    s_lshl_b32 s7, s5, 2
    s_add_u32 s7, s7, s6
    v_and_b32 v9, 3, v2
    s_and_b32 s98, s3, 3
    s_lshl_b32 s100, s98, 11
    s_cmp_lt_u32 s3, 4
    s_cbranch_scc1 L_compute
    s_and_b32 s62, s4, 3
    s_cmp_eq_u32 s62, 1
    s_cbranch_scc1 L_var1
    s_and_b32 s62, s4, 3
    s_cmp_eq_u32 s62, 2
    s_cbranch_scc1 L_var2
    s_and_b32 s62, s4, 3
    s_cmp_eq_u32 s62, 3
    s_cbranch_scc1 L_var3
    v_lshlrev_b32 v3, 4, v9
    v_add_u32 v4, 0, v1
    v_mul_u32_u24 v5, 2731, v4
    v_lshrrev_b32 v5, 16, v5
    v_mul_u32_u24 v6, 24, v5
    v_sub_u32 v6, v4, v6
    v_bfe_u32 v7, v5, 1, 1
    v_lshlrev_b32 v7, 1, v7
    v_xor_b32 v6, v6, v7
    v_add_u32 v5, v5, v3
    v_mul_u32_u24 v5, 12288, v5
    v_lshl_add_u32 v24, v6, 4, v5
    v_add_u32 v27, 98304, v24
    v_xor_b32 v27, 64, v27
    v_add_u32 v4, 64, v1
    v_mul_u32_u24 v5, 2731, v4
    v_lshrrev_b32 v5, 16, v5
    v_mul_u32_u24 v6, 24, v5
    v_sub_u32 v6, v4, v6
    v_bfe_u32 v7, v5, 1, 1
    v_lshlrev_b32 v7, 1, v7
    v_xor_b32 v6, v6, v7
    v_add_u32 v5, v5, v3
    v_mul_u32_u24 v5, 12288, v5
    v_lshl_add_u32 v25, v6, 4, v5
    v_add_u32 v28, 98304, v25
    v_xor_b32 v28, 64, v28
    v_add_u32 v4, 128, v1
    v_mul_u32_u24 v5, 2731, v4
    v_lshrrev_b32 v5, 16, v5
    v_mul_u32_u24 v6, 24, v5
    v_sub_u32 v6, v4, v6
    v_bfe_u32 v7, v5, 1, 1
    v_lshlrev_b32 v7, 1, v7
    v_xor_b32 v6, v6, v7
    v_add_u32 v5, v5, v3
    v_mul_u32_u24 v5, 12288, v5
    v_lshl_add_u32 v26, v6, 4, v5
    v_add_u32 v29, 98304, v26
    v_xor_b32 v29, 64, v29
    v_lshrrev_b32 v5, 3, v1
    v_and_b32 v6, 7, v1
    v_lshrrev_b32 v7, 1, v5
    v_xor_b32 v6, v6, v7
    v_add_u32 v5, v5, v3
    v_mul_u32_u24 v7, 1280, v5
    v_lshl_add_u32 v30, v6, 4, v7
    v_add_u32 v31, 10240, v30
    v_xor_b32 v31, 64, v31
    v_mul_u32_u24 v7, 384, v5
    v_lshl_add_u32 v45, v6, 4, v7
    v_add_u32 v46, 3072, v45
    v_xor_b32 v46, 64, v46
    s_mul_i32 s59, s98, 6144
    s_mul_i32 s60, s98, 5120
    s_mov_b32 s56, s4
    s_mul_i32 s62, s4, 81920
    s_mul_i32 s63, s7, 384
    s_waitcnt lgkmcnt(0)
    s_add_u32 s8, s40, s62
    s_addc_u32 s9, s41, 0
    s_mov_b32 s10, 81920
    s_mov_b32 s11, 0x00020000
    s_add_u32 s12, s46, s63
    s_addc_u32 s13, s47, 0
    s_mov_b32 s14, 7852416
    s_mov_b32 s15, 0x00020000
    s_mul_i32 s57, s56, 786432
    s_lshl_b32 s58, s56, 7
    s_add_u32 m0, s59, 0
    s_nop 0
    buffer_load_dwordx4 v24, s[12:15], s57 offen lds
    s_add_u32 m0, s59, 1024
    s_nop 0
    buffer_load_dwordx4 v25, s[12:15], s57 offen lds
    s_add_u32 m0, s59, 2048
    s_nop 0
    buffer_load_dwordx4 v26, s[12:15], s57 offen lds
    s_add_u32 m0, s59, 3072
    s_nop 0
    buffer_load_dwordx4 v27, s[12:15], s57 offen lds
    s_add_u32 m0, s59, 4096
    s_nop 0
    buffer_load_dwordx4 v28, s[12:15], s57 offen lds
    s_add_u32 m0, s59, 5120
    s_nop 0
    buffer_load_dwordx4 v29, s[12:15], s57 offen lds
    s_add_u32 m0, s100, 24576
    s_nop 0
    buffer_load_dwordx4 v30, s[8:11], s58 offen lds
    s_add_u32 m0, s100, 25600
    s_nop 0
    buffer_load_dwordx4 v31, s[8:11], s58 offen lds
    s_add_u32 s56, s56, 1
    s_cmp_ge_u32 s56, 10
    s_cselect_b32 s56, 0, s56
    v_and_b32 v12, 15, v1
    v_lshrrev_b32 v13, 4, v1
    v_lshlrev_b32 v10, 4, v1
    v_lshlrev_b32 v11, 3, v1
    s_mul_i32 s62, s6, 160
    s_mul_i32 s63, s98, 40
    s_add_u32 s62, s62, s63
    v_min_u32 v4, 39, v1
    v_add_u32 v4, s62, v4
    v_lshlrev_b32 v19, 7, v4
    s_mul_i32 s62, s4, 48
    s_mul_i32 s63, s98, 12
    s_add_u32 s62, s62, s63
    v_min_u32 v4, 11, v1
    v_add_u32 v4, s62, v4
    v_mul_u32_u24 v5, 21846, v4
    v_lshrrev_b32 v5, 16, v5
    v_mul_u32_u24 v6, 3, v5
    v_sub_u32 v6, v4, v6
    v_add_u32 v5, 512, v5
    v_mul_u32_u24 v5, 12288, v5
    v_lshl_add_u32 v20, v6, 7, v5
    buffer_load_dword v80, v19, s[8:11], 0 offen
    buffer_load_dword v81, v20, s[12:15], 0 offen
    s_lshl_b32 s62, s4, 5
    s_add_u32 s63, s62, s7
    s_mul_i32 s63, s63, 24576
    s_add_u32 s16, s42, s63
    s_addc_u32 s17, s43, 0
    s_mov_b32 s18, 24576
    s_mov_b32 s19, 0x00020000
    s_lshl_b32 s63, s5, 2
    s_add_u32 s63, s63, s62
    s_mul_i32 s63, s63, 24576
    s_add_u32 s20, s44, s63
    s_addc_u32 s21, s45, 0
    s_mov_b32 s22, 98304
    s_mov_b32 s23, 0x00020000
    s_mul_i32 s62, s5, 983040
    s_mul_i32 s63, s6, 320
    s_add_u32 s62, s62, s63
    s_add_u32 s24, s48, s62
    s_addc_u32 s25, s49, 0
    s_mov_b32 s26, 982080
    s_mov_b32 s27, 0x00020000
    s_mov_b32 s32, s50
    s_mov_b32 s33, s51
    s_mov_b32 s34, 655360
    s_mov_b32 s35, 0x00020000
    s_mov_b32 s36, s52
    s_mov_b32 s37, s53
    s_mov_b32 s38, 256
    s_mov_b32 s39, 0x00020000
    s_mov_b32 s28, s54
    s_mov_b32 s29, s55
    s_mov_b32 s30, 268435456
    s_mov_b32 s31, 0x00020000
    s_lshl_b32 s62, s4, 5
    s_add_u32 s62, s62, s7
    s_lshl_b32 s45, s62, 13
    s_lshl_b32 s63, s62, 7
    s_add_u32 s53, s63, 8388608
    s_lshl_b32 s62, s4, 5
    s_lshl_b32 s63, s5, 2
    s_add_u32 s63, s63, s62
    s_lshl_b32 s63, s63, 7
    s_add_u32 s43, s63, 8388608
    s_lshl_b32 s62, s4, 2
    s_add_u32 s62, s62, s6
    s_lshl_b32 s63, s62, 3
    s_add_u32 s63, s63, s5
    s_mul_i32 s63, s63, 20480
    s_add_u32 s63, s63, 2097152
    s_mul_i32 s50, s98, 5120
    s_add_u32 s50, s50, s63
    s_mul_i32 s62, s62, 163840
    s_mul_i32 s63, s5, 2560
    s_add_u32 s62, s62, s63
    s_add_u32 s51, s62, 2097152
    s_lshr_b32 s62, s5, 2
    s_lshl_b32 s62, s62, 1
    s_and_b32 s63, s5, 1
    s_add_u32 s62, s62, s63
    s_lshl_b32 s62, s62, 4
    s_lshl_b32 s63, s4, 6
    s_add_u32 s62, s62, s63
    s_mul_i32 s62, s62, 1280
    s_mul_i32 s63, s6, 320
    s_add_u32 s62, s62, s63
    s_lshr_b32 s63, s5, 1
    s_and_b32 s63, s63, 1
    s_mul_i32 s63, s63, 160
    s_add_u32 s52, s62, s63
    s_mov_b32 s49, 0xfffffffe
    s_lshl_b32 s62, s4, 5
    s_add_u32 s62, s62, s6
    s_lshl_b32 s62, s62, 7
    s_add_u32 s42, s62, 8388608
    s_lshr_b32 s62, s4, 1
    s_add_u32 s62, s62, s6
    s_and_b32 s61, s62, 3
    s_and_b32 s62, s4, 1
    s_lshl_b32 s41, s62, 1
    v_add_u32 v4, 0, v1
    v_mul_u32_u24 v5, 2731, v4
    v_lshrrev_b32 v5, 16, v5
    v_mul_u32_u24 v6, 24, v5
    v_sub_u32 v6, v4, v6
    v_bfe_u32 v7, v5, 1, 3
    v_xor_b32 v6, v6, v7
    v_add_u32 v5, v5, v3
    v_mul_u32_u24 v5, 384, v5
    v_lshl_add_u32 v32, v6, 4, v5
    v_add_u32 v4, 64, v1
    v_mul_u32_u24 v5, 2731, v4
    v_lshrrev_b32 v5, 16, v5
    v_mul_u32_u24 v6, 24, v5
    v_sub_u32 v6, v4, v6
    v_bfe_u32 v7, v5, 1, 3
    v_xor_b32 v6, v6, v7
    v_add_u32 v5, v5, v3
    v_mul_u32_u24 v5, 384, v5
    v_lshl_add_u32 v33, v6, 4, v5
    v_add_u32 v4, 128, v1
    v_mul_u32_u24 v5, 2731, v4
    v_lshrrev_b32 v5, 16, v5
    v_mul_u32_u24 v6, 24, v5
    v_sub_u32 v6, v4, v6
    v_bfe_u32 v7, v5, 1, 3
    v_xor_b32 v6, v6, v7
    v_add_u32 v5, v5, v3
    v_mul_u32_u24 v5, 384, v5
    v_lshl_add_u32 v34, v6, 4, v5
    v_add_u32 v4, 192, v1
    v_mul_u32_u24 v5, 2731, v4
    v_lshrrev_b32 v5, 16, v5
    v_mul_u32_u24 v6, 24, v5
    v_sub_u32 v6, v4, v6
    v_bfe_u32 v7, v5, 1, 3
    v_xor_b32 v6, v6, v7
    v_add_u32 v5, v5, v3
    v_mul_u32_u24 v5, 384, v5
    v_lshl_add_u32 v35, v6, 4, v5
    v_add_u32 v4, 256, v1
    v_mul_u32_u24 v5, 2731, v4
    v_lshrrev_b32 v5, 16, v5
    v_mul_u32_u24 v6, 24, v5
    v_sub_u32 v6, v4, v6
    v_bfe_u32 v7, v5, 1, 3
    v_xor_b32 v6, v6, v7
    v_add_u32 v5, v5, v3
    v_mul_u32_u24 v5, 384, v5
    v_lshl_add_u32 v36, v6, 4, v5
    v_add_u32 v4, 320, v1
    v_mul_u32_u24 v5, 2731, v4
    v_lshrrev_b32 v5, 16, v5
    v_mul_u32_u24 v6, 24, v5
    v_sub_u32 v6, v4, v6
    v_bfe_u32 v7, v5, 1, 3
    v_xor_b32 v6, v6, v7
    v_add_u32 v5, v5, v3
    v_mul_u32_u24 v5, 384, v5
    v_lshl_add_u32 v37, v6, 4, v5
    v_add_u32 v4, 0, v1
    v_mul_u32_u24 v5, 3277, v4
    v_lshrrev_b32 v5, 16, v5
    v_mul_u32_u24 v6, 20, v5
    v_sub_u32 v6, v4, v6
    v_bfe_u32 v7, v5, 3, 1
    v_lshlrev_b32 v7, 1, v7
    v_xor_b32 v6, v6, v7
    v_add_u32 v5, v5, v3
    v_mul_u32_u24 v5, 1280, v5
    v_lshl_add_u32 v40, v6, 4, v5
    v_add_u32 v4, 64, v1
    v_mul_u32_u24 v5, 3277, v4
    v_lshrrev_b32 v5, 16, v5
    v_mul_u32_u24 v6, 20, v5
    v_sub_u32 v6, v4, v6
    v_bfe_u32 v7, v5, 3, 1
    v_lshlrev_b32 v7, 1, v7
    v_xor_b32 v6, v6, v7
    v_add_u32 v5, v5, v3
    v_mul_u32_u24 v5, 1280, v5
    v_lshl_add_u32 v41, v6, 4, v5
    v_add_u32 v4, 128, v1
    v_mul_u32_u24 v5, 3277, v4
    v_lshrrev_b32 v5, 16, v5
    v_mul_u32_u24 v6, 20, v5
    v_sub_u32 v6, v4, v6
    v_bfe_u32 v7, v5, 3, 1
    v_lshlrev_b32 v7, 1, v7
    v_xor_b32 v6, v6, v7
    v_add_u32 v5, v5, v3
    v_mul_u32_u24 v5, 1280, v5
    v_lshl_add_u32 v42, v6, 4, v5
    v_add_u32 v4, 192, v1
    v_mul_u32_u24 v5, 3277, v4
    v_lshrrev_b32 v5, 16, v5
    v_mul_u32_u24 v6, 20, v5
    v_sub_u32 v6, v4, v6
    v_bfe_u32 v7, v5, 3, 1
    v_lshlrev_b32 v7, 1, v7
    v_xor_b32 v6, v6, v7
    v_add_u32 v5, v5, v3
    v_mul_u32_u24 v5, 1280, v5
    v_lshl_add_u32 v43, v6, 4, v5
    v_add_u32 v4, 256, v1
    v_mul_u32_u24 v5, 3277, v4
    v_lshrrev_b32 v5, 16, v5
    v_mul_u32_u24 v6, 20, v5
    v_sub_u32 v6, v4, v6
    v_bfe_u32 v7, v5, 3, 1
    v_lshlrev_b32 v7, 1, v7
    v_xor_b32 v6, v6, v7
    v_add_u32 v5, v5, v3
    v_mul_u32_u24 v5, 1280, v5
    v_lshl_add_u32 v44, v6, 4, v5
    v_mov_b32 v16, 0
    v_mov_b32 v22, 0
    v_mov_b32 v84, -1
    v_mov_b32 v85, -1
    v_mov_b32 v86, -1
    v_mov_b32 v87, -1
    s_mul_i32 s57, s56, 786432
    s_lshl_b32 s58, s56, 7
    s_add_u32 m0, s59, 32768
    s_nop 0
    buffer_load_dwordx4 v24, s[12:15], s57 offen lds
    s_add_u32 m0, s59, 33792
    s_nop 0
    buffer_load_dwordx4 v25, s[12:15], s57 offen lds
    s_add_u32 m0, s59, 34816
    s_nop 0
    buffer_load_dwordx4 v26, s[12:15], s57 offen lds
    s_add_u32 m0, s59, 35840
    s_nop 0
    buffer_load_dwordx4 v27, s[12:15], s57 offen lds
    s_add_u32 m0, s59, 36864
    s_nop 0
    buffer_load_dwordx4 v28, s[12:15], s57 offen lds
    s_add_u32 m0, s59, 37888
    s_nop 0
    buffer_load_dwordx4 v29, s[12:15], s57 offen lds
    s_add_u32 m0, s100, 57344
    s_nop 0
    buffer_load_dwordx4 v30, s[8:11], s58 offen lds
    s_add_u32 m0, s100, 58368
    s_nop 0
    buffer_load_dwordx4 v31, s[8:11], s58 offen lds
    s_add_u32 s56, s56, 1
    s_cmp_ge_u32 s56, 10
    s_cselect_b32 s56, 0, s56
    s_waitcnt vmcnt(10)
    s_barrier
    s_mul_i32 s57, s56, 786432
    s_lshl_b32 s58, s56, 7
    s_add_u32 m0, s59, 65536
    s_nop 0
    buffer_load_dwordx4 v24, s[12:15], s57 offen lds
    s_add_u32 m0, s59, 66560
    s_nop 0
    buffer_load_dwordx4 v25, s[12:15], s57 offen lds
    s_add_u32 m0, s59, 67584
    s_nop 0
    buffer_load_dwordx4 v26, s[12:15], s57 offen lds
    s_add_u32 m0, s59, 68608
    s_nop 0
    buffer_load_dwordx4 v27, s[12:15], s57 offen lds
    s_add_u32 m0, s59, 69632
    s_nop 0
    buffer_load_dwordx4 v28, s[12:15], s57 offen lds
    s_add_u32 m0, s59, 70656
    s_nop 0
    buffer_load_dwordx4 v29, s[12:15], s57 offen lds
    s_add_u32 m0, s100, 90112
    s_nop 0
    buffer_load_dwordx4 v30, s[8:11], s58 offen lds
    s_add_u32 m0, s100, 91136
    s_nop 0
    buffer_load_dwordx4 v31, s[8:11], s58 offen lds
    s_add_u32 s56, s56, 1
    s_cmp_ge_u32 s56, 10
    s_cselect_b32 s56, 0, s56
    s_waitcnt vmcnt(8)
    s_barrier
    s_mul_i32 s57, s56, 786432
    s_lshl_b32 s58, s56, 7
    s_add_u32 m0, s59, 0
    s_nop 0
    buffer_load_dwordx4 v24, s[12:15], s57 offen lds
    s_add_u32 m0, s59, 1024
    s_nop 0
    buffer_load_dwordx4 v25, s[12:15], s57 offen lds
    s_add_u32 m0, s59, 2048
    s_nop 0
    buffer_load_dwordx4 v26, s[12:15], s57 offen lds
    s_add_u32 m0, s59, 3072
    s_nop 0
    buffer_load_dwordx4 v27, s[12:15], s57 offen lds
    s_add_u32 m0, s59, 4096
    s_nop 0
    buffer_load_dwordx4 v28, s[12:15], s57 offen lds
    s_add_u32 m0, s59, 5120
    s_nop 0
    buffer_load_dwordx4 v29, s[12:15], s57 offen lds
    s_add_u32 m0, s100, 24576
    s_nop 0
    buffer_load_dwordx4 v30, s[8:11], s58 offen lds
    s_add_u32 m0, s100, 25600
    s_nop 0
    buffer_load_dwordx4 v31, s[8:11], s58 offen lds
    s_add_u32 s56, s56, 1
    s_cmp_ge_u32 s56, 10
    s_cselect_b32 s56, 0, s56
    s_add_u32 m0, s59, 131072
    s_nop 0
    buffer_load_dwordx4 v32, s[16:19], 0 offen nt lds
    s_add_u32 m0, s59, 132096
    s_nop 0
    buffer_load_dwordx4 v33, s[16:19], 0 offen nt lds
    s_add_u32 m0, s59, 133120
    s_nop 0
    buffer_load_dwordx4 v34, s[16:19], 0 offen nt lds
    s_add_u32 m0, s59, 134144
    s_nop 0
    buffer_load_dwordx4 v35, s[16:19], 0 offen nt lds
    s_add_u32 m0, s59, 135168
    s_nop 0
    buffer_load_dwordx4 v36, s[16:19], 0 offen nt lds
    s_add_u32 m0, s59, 136192
    s_nop 0
    buffer_load_dwordx4 v37, s[16:19], 0 offen nt lds
    s_cmp_lg_u32 s98, 0
    s_cbranch_scc1 L_3
    v_lshlrev_b32 v4, 2, v1
    v_mov_b32 v5, 0
    s_mov_b64 s[62:63], exec
    s_mov_b64 exec, 0xff
    buffer_store_dword v5, v4, s[28:31], s53 offen sc1
    s_mov_b64 exec, s[62:63]
L_3:
    s_add_u32 s63, s50, 0
    buffer_store_dwordx4 v[84:87], v10, s[28:31], s63 offen sc1
    s_waitcnt vmcnt(14)
    s_barrier
    s_mul_i32 s57, s56, 786432
    s_lshl_b32 s58, s56, 7
    s_add_u32 m0, s59, 32768
    s_nop 0
    buffer_load_dwordx4 v24, s[12:15], s57 offen lds
    s_add_u32 m0, s59, 33792
    s_nop 0
    buffer_load_dwordx4 v25, s[12:15], s57 offen lds
    s_add_u32 m0, s59, 34816
    s_nop 0
    buffer_load_dwordx4 v26, s[12:15], s57 offen lds
    s_add_u32 m0, s59, 35840
    s_nop 0
    buffer_load_dwordx4 v27, s[12:15], s57 offen lds
    s_add_u32 m0, s59, 36864
    s_nop 0
    buffer_load_dwordx4 v28, s[12:15], s57 offen lds
    s_add_u32 m0, s59, 37888
    s_nop 0
    buffer_load_dwordx4 v29, s[12:15], s57 offen lds
    s_add_u32 m0, s100, 57344
    s_nop 0
    buffer_load_dwordx4 v30, s[8:11], s58 offen lds
    s_add_u32 m0, s100, 58368
    s_nop 0
    buffer_load_dwordx4 v31, s[8:11], s58 offen lds
    s_add_u32 s56, s56, 1
    s_cmp_ge_u32 s56, 10
    s_cselect_b32 s56, 0, s56
    s_add_u32 s63, s50, 1024
    buffer_store_dwordx4 v[84:87], v10, s[28:31], s63 offen sc1
    s_waitcnt vmcnt(14)
    s_barrier
    s_mul_i32 s57, s56, 786432
    s_lshl_b32 s58, s56, 7
    s_add_u32 m0, s59, 65536
    s_nop 0
    buffer_load_dwordx4 v24, s[12:15], s57 offen lds
    s_add_u32 m0, s59, 66560
    s_nop 0
    buffer_load_dwordx4 v25, s[12:15], s57 offen lds
    s_add_u32 m0, s59, 67584
    s_nop 0
    buffer_load_dwordx4 v26, s[12:15], s57 offen lds
    s_add_u32 m0, s59, 68608
    s_nop 0
    buffer_load_dwordx4 v27, s[12:15], s57 offen lds
    s_add_u32 m0, s59, 69632
    s_nop 0
    buffer_load_dwordx4 v28, s[12:15], s57 offen lds
    s_add_u32 m0, s59, 70656
    s_nop 0
    buffer_load_dwordx4 v29, s[12:15], s57 offen lds
    s_add_u32 m0, s100, 90112
    s_nop 0
    buffer_load_dwordx4 v30, s[8:11], s58 offen lds
    s_add_u32 m0, s100, 91136
    s_nop 0
    buffer_load_dwordx4 v31, s[8:11], s58 offen lds
    s_add_u32 s56, s56, 1
    s_cmp_ge_u32 s56, 10
    s_cselect_b32 s56, 0, s56
    s_add_u32 s63, s50, 2048
    buffer_store_dwordx4 v[84:87], v10, s[28:31], s63 offen sc1
    s_waitcnt vmcnt(8)
    s_barrier
    s_mul_i32 s57, s56, 786432
    s_lshl_b32 s58, s56, 7
    s_add_u32 m0, s59, 0
    s_nop 0
    buffer_load_dwordx4 v24, s[12:15], s57 offen lds
    s_add_u32 m0, s59, 1024
    s_nop 0
    buffer_load_dwordx4 v25, s[12:15], s57 offen lds
    s_add_u32 m0, s59, 2048
    s_nop 0
    buffer_load_dwordx4 v26, s[12:15], s57 offen lds
    s_add_u32 m0, s59, 3072
    s_nop 0
    buffer_load_dwordx4 v27, s[12:15], s57 offen lds
    s_add_u32 m0, s59, 4096
    s_nop 0
    buffer_load_dwordx4 v28, s[12:15], s57 offen lds
    s_add_u32 m0, s59, 5120
    s_nop 0
    buffer_load_dwordx4 v29, s[12:15], s57 offen lds
    s_add_u32 m0, s100, 24576
    s_nop 0
    buffer_load_dwordx4 v30, s[8:11], s58 offen lds
    s_add_u32 m0, s100, 25600
    s_nop 0
    buffer_load_dwordx4 v31, s[8:11], s58 offen lds
    s_add_u32 s56, s56, 1
    s_cmp_ge_u32 s56, 10
    s_cselect_b32 s56, 0, s56
    s_add_u32 s63, s50, 3072
    buffer_store_dwordx4 v[84:87], v10, s[28:31], s63 offen sc1
    s_waitcnt vmcnt(8)
    s_barrier
    s_mul_i32 s57, s56, 786432
    s_lshl_b32 s58, s56, 7
    s_add_u32 m0, s59, 32768
    s_nop 0
    buffer_load_dwordx4 v24, s[12:15], s57 offen lds
    s_add_u32 m0, s59, 33792
    s_nop 0
    buffer_load_dwordx4 v25, s[12:15], s57 offen lds
    s_add_u32 m0, s59, 34816
    s_nop 0
    buffer_load_dwordx4 v26, s[12:15], s57 offen lds
    s_add_u32 m0, s59, 35840
    s_nop 0
    buffer_load_dwordx4 v27, s[12:15], s57 offen lds
    s_add_u32 m0, s59, 36864
    s_nop 0
    buffer_load_dwordx4 v28, s[12:15], s57 offen lds
    s_add_u32 m0, s59, 37888
    s_nop 0
    buffer_load_dwordx4 v29, s[12:15], s57 offen lds
    s_add_u32 m0, s100, 57344
    s_nop 0
    buffer_load_dwordx4 v30, s[8:11], s58 offen lds
    s_add_u32 m0, s100, 58368
    s_nop 0
    buffer_load_dwordx4 v31, s[8:11], s58 offen lds
    s_add_u32 s56, s56, 1
    s_cmp_ge_u32 s56, 10
    s_cselect_b32 s56, 0, s56
    s_add_u32 s62, s61, 0
    s_and_b32 s62, s62, 3
    s_add_u32 s63, s41, 0
    s_cmp_ge_u32 s63, 3
    s_cselect_b32 s46, 3, 0
    s_sub_u32 s63, s63, s46
    s_mul_i32 s40, s62, 245760
    s_mul_i32 s46, s63, 81920
    s_add_u32 s40, s40, s46
    s_mul_i32 s101, s62, 24576
    s_lshl_b32 s46, s63, 7
    s_add_u32 s101, s101, s46
    s_add_u32 m0, s60, 98304
    s_nop 0
    buffer_load_dwordx4 v40, s[24:27], s40 offen lds
    s_add_u32 m0, s60, 99328
    s_nop 0
    buffer_load_dwordx4 v41, s[24:27], s40 offen lds
    s_add_u32 m0, s60, 100352
    s_nop 0
    buffer_load_dwordx4 v42, s[24:27], s40 offen lds
    s_add_u32 m0, s60, 101376
    s_nop 0
    buffer_load_dwordx4 v43, s[24:27], s40 offen lds
    s_add_u32 m0, s60, 102400
    s_nop 0
    buffer_load_dwordx4 v44, s[24:27], s40 offen lds
    s_add_u32 m0, s100, 118784
    s_nop 0
    buffer_load_dwordx4 v45, s[20:23], s101 offen lds
    s_add_u32 m0, s100, 119808
    s_nop 0
    buffer_load_dwordx4 v46, s[20:23], s101 offen lds
    s_add_u32 s63, s50, 4096
    buffer_store_dwordx4 v[84:87], v10, s[28:31], s63 offen sc1
    s_waitcnt vmcnt(15)
    s_waitcnt vmcnt(39)
    s_barrier
    s_mul_i32 s57, s56, 786432
    s_lshl_b32 s58, s56, 7
    s_add_u32 m0, s59, 65536
    s_nop 0
    buffer_load_dwordx4 v24, s[12:15], s57 offen lds
    s_add_u32 m0, s59, 66560
    s_nop 0
    buffer_load_dwordx4 v25, s[12:15], s57 offen lds
    s_add_u32 m0, s59, 67584
    s_nop 0
    buffer_load_dwordx4 v26, s[12:15], s57 offen lds
    s_add_u32 m0, s59, 68608
    s_nop 0
    buffer_load_dwordx4 v27, s[12:15], s57 offen lds
    s_add_u32 m0, s59, 69632
    s_nop 0
    buffer_load_dwordx4 v28, s[12:15], s57 offen lds
    s_add_u32 m0, s59, 70656
    s_nop 0
    buffer_load_dwordx4 v29, s[12:15], s57 offen lds
    s_add_u32 m0, s100, 90112
    s_nop 0
    buffer_load_dwordx4 v30, s[8:11], s58 offen lds
    s_add_u32 m0, s100, 91136
    s_nop 0
    buffer_load_dwordx4 v31, s[8:11], s58 offen lds
    s_add_u32 s56, s56, 1
    s_cmp_ge_u32 s56, 10
    s_cselect_b32 s56, 0, s56
    s_waitcnt vmcnt(15)
    s_barrier
    s_mul_i32 s57, s56, 786432
    s_lshl_b32 s58, s56, 7
    s_add_u32 m0, s59, 0
    s_nop 0
    buffer_load_dwordx4 v24, s[12:15], s57 offen lds
    s_add_u32 m0, s59, 1024
    s_nop 0
    buffer_load_dwordx4 v25, s[12:15], s57 offen lds
    s_add_u32 m0, s59, 2048
    s_nop 0
    buffer_load_dwordx4 v26, s[12:15], s57 offen lds
    s_add_u32 m0, s59, 3072
    s_nop 0
    buffer_load_dwordx4 v27, s[12:15], s57 offen lds
    s_add_u32 m0, s59, 4096
    s_nop 0
    buffer_load_dwordx4 v28, s[12:15], s57 offen lds
    s_add_u32 m0, s59, 5120
    s_nop 0
    buffer_load_dwordx4 v29, s[12:15], s57 offen lds
    s_add_u32 m0, s100, 24576
    s_nop 0
    buffer_load_dwordx4 v30, s[8:11], s58 offen lds
    s_add_u32 m0, s100, 25600
    s_nop 0
    buffer_load_dwordx4 v31, s[8:11], s58 offen lds
    s_add_u32 s56, s56, 1
    s_cmp_ge_u32 s56, 10
    s_cselect_b32 s56, 0, s56
    s_waitcnt vmcnt(8)
    s_barrier
    s_add_u32 s62, s61, 0
    s_and_b32 s62, s62, 3
    s_add_u32 s63, s41, 1
    s_cmp_ge_u32 s63, 3
    s_cselect_b32 s46, 3, 0
    s_sub_u32 s63, s63, s46
    s_mul_i32 s40, s62, 245760
    s_mul_i32 s46, s63, 81920
    s_add_u32 s40, s40, s46
    s_mul_i32 s101, s62, 24576
    s_lshl_b32 s46, s63, 7
    s_add_u32 s101, s101, s46
    s_add_u32 m0, s60, 32768
    s_nop 0
    buffer_load_dwordx4 v40, s[24:27], s40 offen lds
    s_add_u32 m0, s60, 33792
    s_nop 0
    buffer_load_dwordx4 v41, s[24:27], s40 offen lds
    s_add_u32 m0, s60, 34816
    s_nop 0
    buffer_load_dwordx4 v42, s[24:27], s40 offen lds
    s_add_u32 m0, s60, 35840
    s_nop 0
    buffer_load_dwordx4 v43, s[24:27], s40 offen lds
    s_add_u32 m0, s60, 36864
    s_nop 0
    buffer_load_dwordx4 v44, s[24:27], s40 offen lds
    s_add_u32 m0, s100, 53248
    s_nop 0
    buffer_load_dwordx4 v45, s[20:23], s101 offen lds
    s_add_u32 m0, s100, 54272
    s_nop 0
    buffer_load_dwordx4 v46, s[20:23], s101 offen lds
    s_add_u32 s62, s61, 0
    s_and_b32 s62, s62, 3
    s_add_u32 s63, s41, 2
    s_cmp_ge_u32 s63, 3
    s_cselect_b32 s46, 3, 0
    s_sub_u32 s63, s63, s46
    s_mul_i32 s40, s62, 245760
    s_mul_i32 s46, s63, 81920
    s_add_u32 s40, s40, s46
    s_mul_i32 s101, s62, 24576
    s_lshl_b32 s46, s63, 7
    s_add_u32 s101, s101, s46
    v_and_b32 v4, 15, v1
    v_add_u32 v4, v4, v3
    v_mul_u32_u24 v4, 384, v4
    buffer_load_dword v82, v4, s[20:23], s101 offen
    s_waitcnt vmcnt(8)
    s_barrier
    s_add_u32 s62, s61, 0
    s_and_b32 s62, s62, 3
    s_add_u32 s63, s41, 2
    s_cmp_ge_u32 s63, 3
    s_cselect_b32 s46, 3, 0
    s_sub_u32 s63, s63, s46
    s_mul_i32 s40, s62, 245760
    s_mul_i32 s46, s63, 81920
    s_add_u32 s40, s40, s46
    s_mul_i32 s101, s62, 24576
    s_lshl_b32 s46, s63, 7
    s_add_u32 s101, s101, s46
    s_add_u32 m0, s60, 65536
    s_nop 0
    buffer_load_dwordx4 v40, s[24:27], s40 offen lds
    s_add_u32 m0, s60, 66560
    s_nop 0
    buffer_load_dwordx4 v41, s[24:27], s40 offen lds
    s_add_u32 m0, s60, 67584
    s_nop 0
    buffer_load_dwordx4 v42, s[24:27], s40 offen lds
    s_add_u32 m0, s60, 68608
    s_nop 0
    buffer_load_dwordx4 v43, s[24:27], s40 offen lds
    s_add_u32 m0, s60, 69632
    s_nop 0
    buffer_load_dwordx4 v44, s[24:27], s40 offen lds
    s_add_u32 m0, s100, 86016
    s_nop 0
    buffer_load_dwordx4 v45, s[20:23], s101 offen lds
    s_add_u32 m0, s100, 87040
    s_nop 0
    buffer_load_dwordx4 v46, s[20:23], s101 offen lds
    s_waitcnt vmcnt(31)
    s_waitcnt vmcnt(31)
    s_barrier
    s_cmp_lg_u32 s98, 0
    s_cbranch_scc1 L_4
    s_lshl_b32 s62, s4, 5
    v_mov_b32 v4, s62
    v_mov_b32 v5, 1
    s_mov_b64 s[62:63], exec
    s_mov_b64 exec, 1
    buffer_atomic_add v5, v4, s[36:39], 0 offen offset:0 sc1
    s_mov_b64 exec, s[62:63]
L_4:
    s_waitcnt vmcnt(8)
    s_barrier
    s_add_u32 s62, s61, 1
    s_and_b32 s62, s62, 3
    s_add_u32 s63, s41, 0
    s_cmp_ge_u32 s63, 3
    s_cselect_b32 s46, 3, 0
    s_sub_u32 s63, s63, s46
    s_mul_i32 s40, s62, 245760
    s_mul_i32 s46, s63, 81920
    s_add_u32 s40, s40, s46
    s_mul_i32 s101, s62, 24576
    s_lshl_b32 s46, s63, 7
    s_add_u32 s101, s101, s46
    s_add_u32 m0, s60, 98304
    s_nop 0
    buffer_load_dwordx4 v40, s[24:27], s40 offen lds
    s_add_u32 m0, s60, 99328
    s_nop 0
    buffer_load_dwordx4 v41, s[24:27], s40 offen lds
    s_add_u32 m0, s60, 100352
    s_nop 0
    buffer_load_dwordx4 v42, s[24:27], s40 offen lds
    s_add_u32 m0, s60, 101376
    s_nop 0
    buffer_load_dwordx4 v43, s[24:27], s40 offen lds
    s_add_u32 m0, s60, 102400
    s_nop 0
    buffer_load_dwordx4 v44, s[24:27], s40 offen lds
    s_add_u32 m0, s100, 118784
    s_nop 0
    buffer_load_dwordx4 v45, s[20:23], s101 offen lds
    s_add_u32 m0, s100, 119808
    s_nop 0
    buffer_load_dwordx4 v46, s[20:23], s101 offen lds
    s_waitcnt vmcnt(7)
    s_barrier
    s_add_u32 s62, s61, 1
    s_and_b32 s62, s62, 3
    s_add_u32 s63, s41, 1
    s_cmp_ge_u32 s63, 3
    s_cselect_b32 s46, 3, 0
    s_sub_u32 s63, s63, s46
    s_mul_i32 s40, s62, 245760
    s_mul_i32 s46, s63, 81920
    s_add_u32 s40, s40, s46
    s_mul_i32 s101, s62, 24576
    s_lshl_b32 s46, s63, 7
    s_add_u32 s101, s101, s46
    s_add_u32 m0, s60, 0
    s_nop 0
    buffer_load_dwordx4 v40, s[24:27], s40 offen lds
    s_add_u32 m0, s60, 1024
    s_nop 0
    buffer_load_dwordx4 v41, s[24:27], s40 offen lds
    s_add_u32 m0, s60, 2048
    s_nop 0
    buffer_load_dwordx4 v42, s[24:27], s40 offen lds
    s_add_u32 m0, s60, 3072
    s_nop 0
    buffer_load_dwordx4 v43, s[24:27], s40 offen lds
    s_add_u32 m0, s60, 4096
    s_nop 0
    buffer_load_dwordx4 v44, s[24:27], s40 offen lds
    s_add_u32 m0, s100, 20480
    s_nop 0
    buffer_load_dwordx4 v45, s[20:23], s101 offen lds
    s_add_u32 m0, s100, 21504
    s_nop 0
    buffer_load_dwordx4 v46, s[20:23], s101 offen lds
    s_add_u32 s62, s61, 1
    s_and_b32 s62, s62, 3
    s_add_u32 s63, s41, 2
    s_cmp_ge_u32 s63, 3
    s_cselect_b32 s46, 3, 0
    s_sub_u32 s63, s63, s46
    s_mul_i32 s40, s62, 245760
    s_mul_i32 s46, s63, 81920
    s_add_u32 s40, s40, s46
    s_mul_i32 s101, s62, 24576
    s_lshl_b32 s46, s63, 7
    s_add_u32 s101, s101, s46
    s_add_u32 m0, s60, 131072
    s_nop 0
    buffer_load_dwordx4 v40, s[24:27], s40 offen lds
    s_add_u32 m0, s60, 132096
    s_nop 0
    buffer_load_dwordx4 v41, s[24:27], s40 offen lds
    s_add_u32 m0, s60, 133120
    s_nop 0
    buffer_load_dwordx4 v42, s[24:27], s40 offen lds
    s_add_u32 m0, s60, 134144
    s_nop 0
    buffer_load_dwordx4 v43, s[24:27], s40 offen lds
    s_add_u32 m0, s60, 135168
    s_nop 0
    buffer_load_dwordx4 v44, s[24:27], s40 offen lds
    s_add_u32 m0, s100, 151552
    s_nop 0
    buffer_load_dwordx4 v45, s[20:23], s101 offen lds
    s_add_u32 m0, s100, 152576
    s_nop 0
    buffer_load_dwordx4 v46, s[20:23], s101 offen lds
    s_waitcnt vmcnt(14)
    s_barrier
    s_add_u32 s62, s61, 2
    s_and_b32 s62, s62, 3
    s_add_u32 s63, s41, 0
    s_cmp_ge_u32 s63, 3
    s_cselect_b32 s46, 3, 0
    s_sub_u32 s63, s63, s46
    s_mul_i32 s40, s62, 245760
    s_mul_i32 s46, s63, 81920
    s_add_u32 s40, s40, s46
    s_mul_i32 s101, s62, 24576
    s_lshl_b32 s46, s63, 7
    s_add_u32 s101, s101, s46
    s_add_u32 m0, s60, 32768
    s_nop 0
    buffer_load_dwordx4 v40, s[24:27], s40 offen lds
    s_add_u32 m0, s60, 33792
    s_nop 0
    buffer_load_dwordx4 v41, s[24:27], s40 offen lds
    s_add_u32 m0, s60, 34816
    s_nop 0
    buffer_load_dwordx4 v42, s[24:27], s40 offen lds
    s_add_u32 m0, s60, 35840
    s_nop 0
    buffer_load_dwordx4 v43, s[24:27], s40 offen lds
    s_add_u32 m0, s60, 36864
    s_nop 0
    buffer_load_dwordx4 v44, s[24:27], s40 offen lds
    s_add_u32 m0, s100, 53248
    s_nop 0
    buffer_load_dwordx4 v45, s[20:23], s101 offen lds
    s_add_u32 m0, s100, 54272
    s_nop 0
    buffer_load_dwordx4 v46, s[20:23], s101 offen lds
    s_waitcnt vmcnt(14)
    s_barrier
    s_add_u32 s62, s61, 2
    s_and_b32 s62, s62, 3
    s_add_u32 s63, s41, 1
    s_cmp_ge_u32 s63, 3
    s_cselect_b32 s46, 3, 0
    s_sub_u32 s63, s63, s46
    s_mul_i32 s40, s62, 245760
    s_mul_i32 s46, s63, 81920
    s_add_u32 s40, s40, s46
    s_mul_i32 s101, s62, 24576
    s_lshl_b32 s46, s63, 7
    s_add_u32 s101, s101, s46
    s_add_u32 m0, s60, 65536
    s_nop 0
    buffer_load_dwordx4 v40, s[24:27], s40 offen lds
    s_add_u32 m0, s60, 66560
    s_nop 0
    buffer_load_dwordx4 v41, s[24:27], s40 offen lds
    s_add_u32 m0, s60, 67584
    s_nop 0
    buffer_load_dwordx4 v42, s[24:27], s40 offen lds
    s_add_u32 m0, s60, 68608
    s_nop 0
    buffer_load_dwordx4 v43, s[24:27], s40 offen lds
    s_add_u32 m0, s60, 69632
    s_nop 0
    buffer_load_dwordx4 v44, s[24:27], s40 offen lds
    s_add_u32 m0, s100, 86016
    s_nop 0
    buffer_load_dwordx4 v45, s[20:23], s101 offen lds
    s_add_u32 m0, s100, 87040
    s_nop 0
    buffer_load_dwordx4 v46, s[20:23], s101 offen lds
    s_waitcnt vmcnt(14)
    s_barrier
    s_cmp_lg_u32 s98, 0
    s_cbranch_scc1 L_5
    s_lshl_b32 s62, s4, 5
    v_mov_b32 v16, s62
    buffer_load_dword v15, v16, s[36:39], 0 offen offset:0 sc1
L_5:
    s_add_u32 s62, s61, 2
    s_and_b32 s62, s62, 3
    s_add_u32 s63, s41, 2
    s_cmp_ge_u32 s63, 3
    s_cselect_b32 s46, 3, 0
    s_sub_u32 s63, s63, s46
    s_mul_i32 s40, s62, 245760
    s_mul_i32 s46, s63, 81920
    s_add_u32 s40, s40, s46
    s_mul_i32 s101, s62, 24576
    s_lshl_b32 s46, s63, 7
    s_add_u32 s101, s101, s46
    s_add_u32 m0, s60, 98304
    s_nop 0
    buffer_load_dwordx4 v40, s[24:27], s40 offen lds
    s_add_u32 m0, s60, 99328
    s_nop 0
    buffer_load_dwordx4 v41, s[24:27], s40 offen lds
    s_add_u32 m0, s60, 100352
    s_nop 0
    buffer_load_dwordx4 v42, s[24:27], s40 offen lds
    s_add_u32 m0, s60, 101376
    s_nop 0
    buffer_load_dwordx4 v43, s[24:27], s40 offen lds
    s_add_u32 m0, s60, 102400
    s_nop 0
    buffer_load_dwordx4 v44, s[24:27], s40 offen lds
    s_add_u32 m0, s100, 118784
    s_nop 0
    buffer_load_dwordx4 v45, s[20:23], s101 offen lds
    s_add_u32 m0, s100, 119808
    s_nop 0
    buffer_load_dwordx4 v46, s[20:23], s101 offen lds
    s_waitcnt vmcnt(14)
    s_barrier
    s_cmp_lg_u32 s98, 0
    s_cbranch_scc1 L_6
    s_waitcnt vmcnt(7)
    s_mov_b32 s48, 0
L_7:
    v_readfirstlane_b32 s62, v15
    s_cmp_ge_u32 s62, 32
    s_cbranch_scc1 L_8
    s_add_u32 s48, s48, 1
    s_cmp_gt_u32 s48, 200000
    s_cbranch_scc1 L_8
    s_sleep 2
    buffer_load_dword v15, v16, s[36:39], 0 offen offset:0 sc1
    s_waitcnt vmcnt(0)
    s_branch L_7
L_8:
L_6:
    s_add_u32 s62, s61, 3
    s_and_b32 s62, s62, 3
    s_add_u32 s63, s41, 0
    s_cmp_ge_u32 s63, 3
    s_cselect_b32 s46, 3, 0
    s_sub_u32 s63, s63, s46
    s_mul_i32 s40, s62, 245760
    s_mul_i32 s46, s63, 81920
    s_add_u32 s40, s40, s46
    s_mul_i32 s101, s62, 24576
    s_lshl_b32 s46, s63, 7
    s_add_u32 s101, s101, s46
    s_add_u32 m0, s60, 0
    s_nop 0
    buffer_load_dwordx4 v40, s[24:27], s40 offen lds
    s_add_u32 m0, s60, 1024
    s_nop 0
    buffer_load_dwordx4 v41, s[24:27], s40 offen lds
    s_add_u32 m0, s60, 2048
    s_nop 0
    buffer_load_dwordx4 v42, s[24:27], s40 offen lds
    s_add_u32 m0, s60, 3072
    s_nop 0
    buffer_load_dwordx4 v43, s[24:27], s40 offen lds
    s_add_u32 m0, s60, 4096
    s_nop 0
    buffer_load_dwordx4 v44, s[24:27], s40 offen lds
    s_add_u32 m0, s100, 20480
    s_nop 0
    buffer_load_dwordx4 v45, s[20:23], s101 offen lds
    s_add_u32 m0, s100, 21504
    s_nop 0
    buffer_load_dwordx4 v46, s[20:23], s101 offen lds
    s_waitcnt vmcnt(14)
    s_barrier
    s_add_u32 s62, s61, s98
    s_and_b32 s62, s62, 3
    s_lshl_b32 s62, s62, 7
    s_add_u32 s56, s62, s43
    v_lshlrev_b32 v18, 2, v1
    buffer_load_dword v17, v18, s[28:31], s56 offen sc1
    s_add_u32 s62, s61, 3
    s_and_b32 s62, s62, 3
    s_add_u32 s63, s41, 1
    s_cmp_ge_u32 s63, 3
    s_cselect_b32 s46, 3, 0
    s_sub_u32 s63, s63, s46
    s_mul_i32 s40, s62, 245760
    s_mul_i32 s46, s63, 81920
    s_add_u32 s40, s40, s46
    s_mul_i32 s101, s62, 24576
    s_lshl_b32 s46, s63, 7
    s_add_u32 s101, s101, s46
    s_add_u32 m0, s60, 131072
    s_nop 0
    buffer_load_dwordx4 v40, s[24:27], s40 offen lds
    s_add_u32 m0, s60, 132096
    s_nop 0
    buffer_load_dwordx4 v41, s[24:27], s40 offen lds
    s_add_u32 m0, s60, 133120
    s_nop 0
    buffer_load_dwordx4 v42, s[24:27], s40 offen lds
    s_add_u32 m0, s60, 134144
    s_nop 0
    buffer_load_dwordx4 v43, s[24:27], s40 offen lds
    s_add_u32 m0, s60, 135168
    s_nop 0
    buffer_load_dwordx4 v44, s[24:27], s40 offen lds
    s_add_u32 m0, s100, 151552
    s_nop 0
    buffer_load_dwordx4 v45, s[20:23], s101 offen lds
    s_add_u32 m0, s100, 152576
    s_nop 0
    buffer_load_dwordx4 v46, s[20:23], s101 offen lds
    s_waitcnt vmcnt(15)
    s_barrier
    s_add_u32 s62, s61, 3
    s_and_b32 s62, s62, 3
    s_add_u32 s63, s41, 2
    s_cmp_ge_u32 s63, 3
    s_cselect_b32 s46, 3, 0
    s_sub_u32 s63, s63, s46
    s_mul_i32 s40, s62, 245760
    s_mul_i32 s46, s63, 81920
    s_add_u32 s40, s40, s46
    s_mul_i32 s101, s62, 24576
    s_lshl_b32 s46, s63, 7
    s_add_u32 s101, s101, s46
    s_add_u32 m0, s60, 32768
    s_nop 0
    buffer_load_dwordx4 v40, s[24:27], s40 offen lds
    s_add_u32 m0, s60, 33792
    s_nop 0
    buffer_load_dwordx4 v41, s[24:27], s40 offen lds
    s_add_u32 m0, s60, 34816
    s_nop 0
    buffer_load_dwordx4 v42, s[24:27], s40 offen lds
    s_add_u32 m0, s60, 35840
    s_nop 0
    buffer_load_dwordx4 v43, s[24:27], s40 offen lds
    s_add_u32 m0, s60, 36864
    s_nop 0
    buffer_load_dwordx4 v44, s[24:27], s40 offen lds
    s_add_u32 m0, s100, 53248
    s_nop 0
    buffer_load_dwordx4 v45, s[20:23], s101 offen lds
    s_add_u32 m0, s100, 54272
    s_nop 0
    buffer_load_dwordx4 v46, s[20:23], s101 offen lds
    s_waitcnt vmcnt(15)
    s_barrier
    s_waitcnt vmcnt(14)
    s_mov_b32 s48, 0
    s_mov_b64 s[62:63], exec
    s_mov_b64 exec, 0xf
L_9:
    v_cmp_ne_u32 vcc, 1, v17
    s_cbranch_vccz L_10
    s_add_u32 s48, s48, 1
    s_cmp_gt_u32 s48, 200000
    s_cbranch_scc1 L_10
    buffer_load_dword v17, v18, s[28:31], s56 offen sc1
    s_waitcnt vmcnt(0)
    s_branch L_9
L_10:
    s_mov_b64 exec, s[62:63]
    s_lshl_b32 s62, s4, 5
    s_lshl_b32 s63, s5, 2
    s_add_u32 s47, s62, s63
    s_add_u32 s62, s61, s98
    s_and_b32 s62, s62, 3
    s_add_u32 s62, s62, s47
    s_lshl_b32 s62, s62, 13
    buffer_load_dwordx4 v[48:51], v10, s[28:31], s62 offen offset:0 sc1
    buffer_load_dwordx4 v[52:55], v10, s[28:31], s62 offen offset:1024 sc1
    buffer_load_dwordx4 v[56:59], v10, s[28:31], s62 offen offset:2048 sc1
    buffer_load_dwordx4 v[60:63], v10, s[28:31], s62 offen offset:3072 sc1
    s_add_u32 s62, s62, 4096
    buffer_load_dwordx4 v[64:67], v10, s[28:31], s62 offen offset:0 sc1
    buffer_load_dwordx4 v[68:71], v10, s[28:31], s62 offen offset:1024 sc1
    buffer_load_dwordx4 v[72:75], v10, s[28:31], s62 offen offset:2048 sc1
    buffer_load_dwordx4 v[76:79], v10, s[28:31], s62 offen offset:3072 sc1
    s_waitcnt vmcnt(15)
    s_barrier
    s_waitcnt vmcnt(8)
    s_barrier
    s_waitcnt vmcnt(0)
    s_lshl_b32 s62, s98, 13
    s_add_u32 s62, s62, 65536
    v_add_u32 v16, s62, v10
    ds_write_b128 v16, v[48:51] offset:0
    ds_write_b128 v16, v[52:55] offset:1024
    ds_write_b128 v16, v[56:59] offset:2048
    ds_write_b128 v16, v[60:63] offset:3072
    ds_write_b128 v16, v[64:67] offset:4096
    ds_write_b128 v16, v[68:71] offset:5120
    ds_write_b128 v16, v[72:75] offset:6144
    ds_write_b128 v16, v[76:79] offset:7168
    s_waitcnt lgkmcnt(0)
    s_barrier
    s_barrier
    s_cmp_lg_u32 s3, 4
    s_cbranch_scc1 L_11
    s_mov_b32 s56, 4
    v_mul_u32_u24 v22, 1280, v12
    v_lshl_add_u32 v22, v13, 3, v22
    s_lshl_b32 s62, s56, 9
    s_add_u32 s47, s51, s62
    s_mov_b32 s48, 0
L_12:
    s_add_u32 s62, s47, 0
    buffer_load_dwordx2 v[48:49], v11, s[28:31], s62 offen sc1
    s_add_u32 s62, s47, 20480
    buffer_load_dwordx2 v[50:51], v11, s[28:31], s62 offen sc1
    s_add_u32 s62, s47, 40960
    buffer_load_dwordx2 v[52:53], v11, s[28:31], s62 offen sc1
    s_add_u32 s62, s47, 61440
    buffer_load_dwordx2 v[54:55], v11, s[28:31], s62 offen sc1
    s_add_u32 s62, s47, 81920
    buffer_load_dwordx2 v[56:57], v11, s[28:31], s62 offen sc1
    s_add_u32 s62, s47, 102400
    buffer_load_dwordx2 v[58:59], v11, s[28:31], s62 offen sc1
    s_add_u32 s62, s47, 122880
    buffer_load_dwordx2 v[60:61], v11, s[28:31], s62 offen sc1
    s_add_u32 s62, s47, 143360
    buffer_load_dwordx2 v[62:63], v11, s[28:31], s62 offen sc1
    s_waitcnt vmcnt(0)
    v_max3_u32 v14, v48, v49, v50
    v_max3_u32 v14, v14, v51, v52
    v_max3_u32 v14, v14, v53, v54
    v_max3_u32 v14, v14, v55, v56
    v_max3_u32 v14, v14, v57, v58
    v_max3_u32 v14, v14, v59, v60
    v_max3_u32 v14, v14, v61, v62
    v_max_u32 v14, v14, v63
    v_cmp_eq_u32 vcc, -1, v14
    s_cbranch_vccz L_13
    s_add_u32 s48, s48, 1
    s_cmp_gt_u32 s48, 200000
    s_cbranch_scc0 L_12
L_13:
    v_lshlrev_b32 v16, 16, v48
    v_and_b32 v17, 0xffff0000, v48
    v_lshlrev_b32 v18, 16, v49
    v_and_b32 v19, 0xffff0000, v49
    v_lshlrev_b32 v20, 16, v50
    v_and_b32 v21, 0xffff0000, v50
    v_add_f32 v16, v16, v20
    v_add_f32 v17, v17, v21
    v_lshlrev_b32 v20, 16, v51
    v_and_b32 v21, 0xffff0000, v51
    v_add_f32 v18, v18, v20
    v_add_f32 v19, v19, v21
    v_lshlrev_b32 v20, 16, v52
    v_and_b32 v21, 0xffff0000, v52
    v_add_f32 v16, v16, v20
    v_add_f32 v17, v17, v21
    v_lshlrev_b32 v20, 16, v53
    v_and_b32 v21, 0xffff0000, v53
    v_add_f32 v18, v18, v20
    v_add_f32 v19, v19, v21
    v_lshlrev_b32 v20, 16, v54
    v_and_b32 v21, 0xffff0000, v54
    v_add_f32 v16, v16, v20
    v_add_f32 v17, v17, v21
    v_lshlrev_b32 v20, 16, v55
    v_and_b32 v21, 0xffff0000, v55
    v_add_f32 v18, v18, v20
    v_add_f32 v19, v19, v21
    v_lshlrev_b32 v20, 16, v56
    v_and_b32 v21, 0xffff0000, v56
    v_add_f32 v16, v16, v20
    v_add_f32 v17, v17, v21
    v_lshlrev_b32 v20, 16, v57
    v_and_b32 v21, 0xffff0000, v57
    v_add_f32 v18, v18, v20
    v_add_f32 v19, v19, v21
    v_lshlrev_b32 v20, 16, v58
    v_and_b32 v21, 0xffff0000, v58
    v_add_f32 v16, v16, v20
    v_add_f32 v17, v17, v21
    v_lshlrev_b32 v20, 16, v59
    v_and_b32 v21, 0xffff0000, v59
    v_add_f32 v18, v18, v20
    v_add_f32 v19, v19, v21
    v_lshlrev_b32 v20, 16, v60
    v_and_b32 v21, 0xffff0000, v60
    v_add_f32 v16, v16, v20
    v_add_f32 v17, v17, v21
    v_lshlrev_b32 v20, 16, v61
    v_and_b32 v21, 0xffff0000, v61
    v_add_f32 v18, v18, v20
    v_add_f32 v19, v19, v21
    v_lshlrev_b32 v20, 16, v62
    v_and_b32 v21, 0xffff0000, v62
    v_add_f32 v16, v16, v20
    v_add_f32 v17, v17, v21
    v_lshlrev_b32 v20, 16, v63
    v_and_b32 v21, 0xffff0000, v63
    v_add_f32 v18, v18, v20
    v_add_f32 v19, v19, v21
    v_cvt_pk_bf16_f32 v20, v16, v17
    v_cvt_pk_bf16_f32 v21, v18, v19
    s_lshl_b32 s62, s56, 5
    s_add_u32 s62, s62, s52
    buffer_store_dwordx2 v[20:21], v22, s[32:35], s62 offen
L_11:
    s_endpgm
L_compute:
    v_and_b32 v12, 15, v1
    v_lshrrev_b32 v13, 4, v1
    v_lshlrev_b32 v10, 4, v1
    v_lshlrev_b32 v11, 3, v1
    v_bfe_u32 v4, v1, 2, 2
    v_and_b32 v5, 3, v1
    v_lshl_add_u32 v6, v13, 3, v4
    v_lshrrev_b32 v7, 1, v4
    v_and_b32 v8, 1, v13
    v_lshl_add_u32 v7, v8, 1, v7
    v_mul_u32_u24 v8, 384, v6
    v_lshl_add_u32 v8, v5, 3, v8
    v_mul_u32_u24 v14, 3, v9
    v_add_u32 v15, 0, v14
    v_xor_b32 v15, v15, v7
    v_lshl_add_u32 v24, v15, 5, v8
    v_add_u32 v15, 1, v14
    v_xor_b32 v15, v15, v7
    v_lshl_add_u32 v25, v15, 5, v8
    v_add_u32 v15, 2, v14
    v_xor_b32 v15, v15, v7
    v_lshl_add_u32 v26, v15, 5, v8
    v_mul_u32_u24 v8, 320, v6
    v_lshl_add_u32 v8, v5, 3, v8
    v_and_b32 v16, 1, v9
    v_mul_u32_u24 v7, 160, v16
    v_add_u32 v8, v8, v7
    v_and_b32 v7, 1, v13
    v_lshlrev_b32 v7, 5, v7
    v_add_u32 v17, v8, v7
    v_sub_u32 v18, v8, v7
    v_cmp_eq_u32 vcc, 0, v16
    s_nop 1
    v_cndmask_b32 v19, v18, v17, vcc
    v_cndmask_b32 v20, v17, v18, vcc
    v_bfe_u32 v7, v12, 1, 3
    v_add_u32 v8, 0, v13
    v_xor_b32 v8, v8, v7
    v_lshlrev_b32 v8, 4, v8
    v_lshl_add_u32 v15, v12, 7, v8
    v_add_u32 v27, 24576, v15
    v_lshrrev_b32 v4, 1, v9
    v_lshlrev_b32 v4, 12, v4
    v_add_u32 v4, v4, v15
    v_add_u32 v21, 20480, v4
    v_mul_u32_u24 v15, 384, v12
    v_add_u32 v37, v15, v8
    v_add_u32 v8, 4, v13
    v_xor_b32 v8, v8, v7
    v_lshlrev_b32 v8, 4, v8
    v_lshl_add_u32 v15, v12, 7, v8
    v_add_u32 v28, 24576, v15
    v_lshrrev_b32 v4, 1, v9
    v_lshlrev_b32 v4, 12, v4
    v_add_u32 v4, v4, v15
    v_add_u32 v22, 20480, v4
    v_mul_u32_u24 v15, 384, v12
    v_add_u32 v38, v15, v8
    v_add_u32 v4, 0, v14
    v_lshlrev_b32 v4, 1, v4
    v_lshrrev_b32 v5, 1, v13
    v_add_u32 v4, v4, v5
    v_xor_b32 v4, v4, v7
    v_lshlrev_b32 v4, 4, v4
    v_and_b32 v5, 1, v13
    v_lshl_add_u32 v4, v5, 3, v4
    v_mul_u32_u24 v5, 384, v12
    v_add_u32 v34, v4, v5
    v_add_u32 v4, 1, v14
    v_lshlrev_b32 v4, 1, v4
    v_lshrrev_b32 v5, 1, v13
    v_add_u32 v4, v4, v5
    v_xor_b32 v4, v4, v7
    v_lshlrev_b32 v4, 4, v4
    v_and_b32 v5, 1, v13
    v_lshl_add_u32 v4, v5, 3, v4
    v_mul_u32_u24 v5, 384, v12
    v_add_u32 v35, v4, v5
    v_add_u32 v4, 2, v14
    v_lshlrev_b32 v4, 1, v4
    v_lshrrev_b32 v5, 1, v13
    v_add_u32 v4, v4, v5
    v_xor_b32 v4, v4, v7
    v_lshlrev_b32 v4, 4, v4
    v_and_b32 v5, 1, v13
    v_lshl_add_u32 v4, v5, 3, v4
    v_mul_u32_u24 v5, 384, v12
    v_add_u32 v36, v4, v5
    v_lshrrev_b32 v5, 1, v9
    v_lshlrev_b32 v4, 10, v5
    v_add_u32 v4, v4, v10
    v_add_u32 v4, 65536, v4
    v_lshl_add_u32 v0, v5, 12, v4
    v_xor_b32 v5, 1, v5
    v_lshl_add_u32 v6, v5, 12, v4
    v_mov_b32 v2, v21
    v_mov_b32 v3, v22
    v_mov_b32 v4, v19
    v_mov_b32 v5, v20
    v_mul_u32_u24 v14, 10240, v9
    v_add_u32 v7, v14, v10
    v_add_u32 v7, 98304, v7
    v_xor_b32 v14, 2, v9
    v_mul_u32_u24 v14, 10240, v14
    v_add_u32 v8, v14, v10
    v_add_u32 v8, 98304, v8
    s_waitcnt lgkmcnt(0)
    s_mov_b32 s32, s50
    s_mov_b32 s33, s51
    s_mov_b32 s34, 655360
    s_mov_b32 s35, 0x00020000
    s_mov_b32 s36, s52
    s_mov_b32 s37, s53
    s_mov_b32 s38, 256
    s_mov_b32 s39, 0x00020000
    s_mov_b32 s28, s54
    s_mov_b32 s29, s55
    s_mov_b32 s30, 268435456
    s_mov_b32 s31, 0x00020000
    s_lshl_b32 s62, s4, 5
    s_add_u32 s62, s62, s7
    s_lshl_b32 s45, s62, 13
    s_lshl_b32 s63, s62, 7
    s_add_u32 s53, s63, 8388608
    s_lshl_b32 s62, s4, 5
    s_lshl_b32 s63, s5, 2
    s_add_u32 s63, s63, s62
    s_lshl_b32 s63, s63, 7
    s_add_u32 s43, s63, 8388608
    s_lshl_b32 s62, s4, 2
    s_add_u32 s62, s62, s6
    s_lshl_b32 s63, s62, 3
    s_add_u32 s63, s63, s5
    s_mul_i32 s63, s63, 20480
    s_add_u32 s63, s63, 2097152
    s_mul_i32 s50, s98, 5120
    s_add_u32 s50, s50, s63
    s_mul_i32 s62, s62, 163840
    s_mul_i32 s63, s5, 2560
    s_add_u32 s62, s62, s63
    s_add_u32 s51, s62, 2097152
    s_lshr_b32 s62, s5, 2
    s_lshl_b32 s62, s62, 1
    s_and_b32 s63, s5, 1
    s_add_u32 s62, s62, s63
    s_lshl_b32 s62, s62, 4
    s_lshl_b32 s63, s4, 6
    s_add_u32 s62, s62, s63
    s_mul_i32 s62, s62, 1280
    s_mul_i32 s63, s6, 320
    s_add_u32 s62, s62, s63
    s_lshr_b32 s63, s5, 1
    s_and_b32 s63, s63, 1
    s_mul_i32 s63, s63, 160
    s_add_u32 s52, s62, s63
    s_mov_b32 s49, 0xfffffffe
    s_lshl_b32 s62, s4, 5
    s_add_u32 s62, s62, s6
    s_lshl_b32 s62, s62, 7
    s_add_u32 s42, s62, 8388608
    v_add_u32 v100, 131072, v37
    v_add_u32 v101, 131072, v38
    s_barrier
    v_add_u32 v29, 0, v24
    v_add_u32 v30, 0, v25
    v_add_u32 v31, 0, v26
    v_add_u32 v32, 0, v27
    v_add_u32 v33, 0, v28
    ds_read_b128 a[12:15], v32 offset:0
    ds_read_b128 a[16:19], v32 offset:2048
    ds_read_b128 a[20:23], v32 offset:4096
    ds_read_b128 a[24:27], v32 offset:6144
    ds_read_b64_tr_b16 a[0:1], v29 offset:0
    ds_read_b64_tr_b16 a[2:3], v29 offset:1536
    ds_read_b64_tr_b16 a[4:5], v30 offset:0
    ds_read_b64_tr_b16 a[6:7], v30 offset:1536
    ds_read_b64_tr_b16 a[8:9], v31 offset:0
    ds_read_b64_tr_b16 a[10:11], v31 offset:1536
    s_waitcnt lgkmcnt(0)
    v_mfma_f32_16x16x32_bf16 v[40:43], a[0:3], a[12:15], 0
    ds_read_b128 a[40:43], v33 offset:0
    ds_read_b128 a[44:47], v33 offset:2048
    v_mfma_f32_16x16x32_bf16 v[44:47], a[0:3], a[16:19], 0
    ds_read_b128 a[48:51], v33 offset:4096
    v_mfma_f32_16x16x32_bf16 v[48:51], a[0:3], a[20:23], 0
    ds_read_b128 a[52:55], v33 offset:6144
    v_mfma_f32_16x16x32_bf16 v[52:55], a[0:3], a[24:27], 0
    ds_read_b64_tr_b16 a[28:29], v29 offset:12288
    v_mfma_f32_16x16x32_bf16 v[56:59], a[4:7], a[12:15], 0
    ds_read_b64_tr_b16 a[30:31], v29 offset:13824
    ds_read_b64_tr_b16 a[32:33], v30 offset:12288
    v_mfma_f32_16x16x32_bf16 v[60:63], a[4:7], a[16:19], 0
    ds_read_b64_tr_b16 a[34:35], v30 offset:13824
    v_mfma_f32_16x16x32_bf16 v[64:67], a[4:7], a[20:23], 0
    ds_read_b64_tr_b16 a[36:37], v31 offset:12288
    v_mfma_f32_16x16x32_bf16 v[68:71], a[4:7], a[24:27], 0
    ds_read_b64_tr_b16 a[38:39], v31 offset:13824
    v_mfma_f32_16x16x32_bf16 v[72:75], a[8:11], a[12:15], 0
    v_mfma_f32_16x16x32_bf16 v[76:79], a[8:11], a[16:19], 0
    v_mfma_f32_16x16x32_bf16 v[80:83], a[8:11], a[20:23], 0
    v_mfma_f32_16x16x32_bf16 v[84:87], a[8:11], a[24:27], 0
    s_waitcnt lgkmcnt(0)
    s_barrier
    v_add_u32 v29, 32768, v24
    v_add_u32 v30, 32768, v25
    v_add_u32 v31, 32768, v26
    v_add_u32 v32, 32768, v27
    v_add_u32 v33, 32768, v28
    v_mfma_f32_16x16x32_bf16 v[40:43], a[28:31], a[40:43], v[40:43]
    ds_read_b128 a[12:15], v32 offset:0
    ds_read_b128 a[16:19], v32 offset:2048
    v_mfma_f32_16x16x32_bf16 v[44:47], a[28:31], a[44:47], v[44:47]
    ds_read_b128 a[20:23], v32 offset:4096
    v_mfma_f32_16x16x32_bf16 v[48:51], a[28:31], a[48:51], v[48:51]
    ds_read_b128 a[24:27], v32 offset:6144
    v_mfma_f32_16x16x32_bf16 v[52:55], a[28:31], a[52:55], v[52:55]
    ds_read_b64_tr_b16 a[0:1], v29 offset:0
    v_mfma_f32_16x16x32_bf16 v[56:59], a[32:35], a[40:43], v[56:59]
    ds_read_b64_tr_b16 a[2:3], v29 offset:1536
    ds_read_b64_tr_b16 a[4:5], v30 offset:0
    v_mfma_f32_16x16x32_bf16 v[60:63], a[32:35], a[44:47], v[60:63]
    ds_read_b64_tr_b16 a[6:7], v30 offset:1536
    v_mfma_f32_16x16x32_bf16 v[64:67], a[32:35], a[48:51], v[64:67]
    ds_read_b64_tr_b16 a[8:9], v31 offset:0
    v_mfma_f32_16x16x32_bf16 v[68:71], a[32:35], a[52:55], v[68:71]
    ds_read_b64_tr_b16 a[10:11], v31 offset:1536
    v_mfma_f32_16x16x32_bf16 v[72:75], a[36:39], a[40:43], v[72:75]
    v_mfma_f32_16x16x32_bf16 v[76:79], a[36:39], a[44:47], v[76:79]
    v_mfma_f32_16x16x32_bf16 v[80:83], a[36:39], a[48:51], v[80:83]
    v_mfma_f32_16x16x32_bf16 v[84:87], a[36:39], a[52:55], v[84:87]
    s_waitcnt lgkmcnt(0)
    v_mfma_f32_16x16x32_bf16 v[40:43], a[0:3], a[12:15], v[40:43]
    ds_read_b128 a[40:43], v33 offset:0
    ds_read_b128 a[44:47], v33 offset:2048
    v_mfma_f32_16x16x32_bf16 v[44:47], a[0:3], a[16:19], v[44:47]
    ds_read_b128 a[48:51], v33 offset:4096
    v_mfma_f32_16x16x32_bf16 v[48:51], a[0:3], a[20:23], v[48:51]
    ds_read_b128 a[52:55], v33 offset:6144
    v_mfma_f32_16x16x32_bf16 v[52:55], a[0:3], a[24:27], v[52:55]
    ds_read_b64_tr_b16 a[28:29], v29 offset:12288
    v_mfma_f32_16x16x32_bf16 v[56:59], a[4:7], a[12:15], v[56:59]
    ds_read_b64_tr_b16 a[30:31], v29 offset:13824
    ds_read_b64_tr_b16 a[32:33], v30 offset:12288
    v_mfma_f32_16x16x32_bf16 v[60:63], a[4:7], a[16:19], v[60:63]
    ds_read_b64_tr_b16 a[34:35], v30 offset:13824
    v_mfma_f32_16x16x32_bf16 v[64:67], a[4:7], a[20:23], v[64:67]
    ds_read_b64_tr_b16 a[36:37], v31 offset:12288
    v_mfma_f32_16x16x32_bf16 v[68:71], a[4:7], a[24:27], v[68:71]
    ds_read_b64_tr_b16 a[38:39], v31 offset:13824
    v_mfma_f32_16x16x32_bf16 v[72:75], a[8:11], a[12:15], v[72:75]
    v_mfma_f32_16x16x32_bf16 v[76:79], a[8:11], a[16:19], v[76:79]
    v_mfma_f32_16x16x32_bf16 v[80:83], a[8:11], a[20:23], v[80:83]
    v_mfma_f32_16x16x32_bf16 v[84:87], a[8:11], a[24:27], v[84:87]
    s_waitcnt lgkmcnt(0)
    s_barrier
    v_add_u32 v29, 65536, v24
    v_add_u32 v30, 65536, v25
    v_add_u32 v31, 65536, v26
    v_add_u32 v32, 65536, v27
    v_add_u32 v33, 65536, v28
    v_mfma_f32_16x16x32_bf16 v[40:43], a[28:31], a[40:43], v[40:43]
    ds_read_b128 a[12:15], v32 offset:0
    ds_read_b128 a[16:19], v32 offset:2048
    v_mfma_f32_16x16x32_bf16 v[44:47], a[28:31], a[44:47], v[44:47]
    ds_read_b128 a[20:23], v32 offset:4096
    v_mfma_f32_16x16x32_bf16 v[48:51], a[28:31], a[48:51], v[48:51]
    ds_read_b128 a[24:27], v32 offset:6144
    v_mfma_f32_16x16x32_bf16 v[52:55], a[28:31], a[52:55], v[52:55]
    ds_read_b64_tr_b16 a[0:1], v29 offset:0
    v_mfma_f32_16x16x32_bf16 v[56:59], a[32:35], a[40:43], v[56:59]
    ds_read_b64_tr_b16 a[2:3], v29 offset:1536
    ds_read_b64_tr_b16 a[4:5], v30 offset:0
    v_mfma_f32_16x16x32_bf16 v[60:63], a[32:35], a[44:47], v[60:63]
    ds_read_b64_tr_b16 a[6:7], v30 offset:1536
    v_mfma_f32_16x16x32_bf16 v[64:67], a[32:35], a[48:51], v[64:67]
    ds_read_b64_tr_b16 a[8:9], v31 offset:0
    v_mfma_f32_16x16x32_bf16 v[68:71], a[32:35], a[52:55], v[68:71]
    ds_read_b64_tr_b16 a[10:11], v31 offset:1536
    v_mfma_f32_16x16x32_bf16 v[72:75], a[36:39], a[40:43], v[72:75]
    v_mfma_f32_16x16x32_bf16 v[76:79], a[36:39], a[44:47], v[76:79]
    v_mfma_f32_16x16x32_bf16 v[80:83], a[36:39], a[48:51], v[80:83]
    v_mfma_f32_16x16x32_bf16 v[84:87], a[36:39], a[52:55], v[84:87]
    s_waitcnt lgkmcnt(0)
    v_mfma_f32_16x16x32_bf16 v[40:43], a[0:3], a[12:15], v[40:43]
    ds_read_b128 a[40:43], v33 offset:0
    ds_read_b128 a[44:47], v33 offset:2048
    v_mfma_f32_16x16x32_bf16 v[44:47], a[0:3], a[16:19], v[44:47]
    ds_read_b128 a[48:51], v33 offset:4096
    v_mfma_f32_16x16x32_bf16 v[48:51], a[0:3], a[20:23], v[48:51]
    ds_read_b128 a[52:55], v33 offset:6144
    v_mfma_f32_16x16x32_bf16 v[52:55], a[0:3], a[24:27], v[52:55]
    ds_read_b64_tr_b16 a[28:29], v29 offset:12288
    v_mfma_f32_16x16x32_bf16 v[56:59], a[4:7], a[12:15], v[56:59]
    ds_read_b64_tr_b16 a[30:31], v29 offset:13824
    ds_read_b64_tr_b16 a[32:33], v30 offset:12288
    v_mfma_f32_16x16x32_bf16 v[60:63], a[4:7], a[16:19], v[60:63]
    ds_read_b64_tr_b16 a[34:35], v30 offset:13824
    v_mfma_f32_16x16x32_bf16 v[64:67], a[4:7], a[20:23], v[64:67]
    ds_read_b64_tr_b16 a[36:37], v31 offset:12288
    v_mfma_f32_16x16x32_bf16 v[68:71], a[4:7], a[24:27], v[68:71]
    ds_read_b64_tr_b16 a[38:39], v31 offset:13824
    v_mfma_f32_16x16x32_bf16 v[72:75], a[8:11], a[12:15], v[72:75]
    v_mfma_f32_16x16x32_bf16 v[76:79], a[8:11], a[16:19], v[76:79]
    v_mfma_f32_16x16x32_bf16 v[80:83], a[8:11], a[20:23], v[80:83]
    v_mfma_f32_16x16x32_bf16 v[84:87], a[8:11], a[24:27], v[84:87]
    s_waitcnt lgkmcnt(0)
    s_barrier
    v_add_u32 v29, 0, v24
    v_add_u32 v30, 0, v25
    v_add_u32 v31, 0, v26
    v_add_u32 v32, 0, v27
    v_add_u32 v33, 0, v28
    v_mfma_f32_16x16x32_bf16 v[40:43], a[28:31], a[40:43], v[40:43]
    ds_read_b128 a[12:15], v32 offset:0
    ds_read_b128 a[16:19], v32 offset:2048
    v_mfma_f32_16x16x32_bf16 v[44:47], a[28:31], a[44:47], v[44:47]
    ds_read_b128 a[20:23], v32 offset:4096
    v_mfma_f32_16x16x32_bf16 v[48:51], a[28:31], a[48:51], v[48:51]
    ds_read_b128 a[24:27], v32 offset:6144
    v_mfma_f32_16x16x32_bf16 v[52:55], a[28:31], a[52:55], v[52:55]
    ds_read_b64_tr_b16 a[0:1], v29 offset:0
    v_mfma_f32_16x16x32_bf16 v[56:59], a[32:35], a[40:43], v[56:59]
    ds_read_b64_tr_b16 a[2:3], v29 offset:1536
    ds_read_b64_tr_b16 a[4:5], v30 offset:0
    v_mfma_f32_16x16x32_bf16 v[60:63], a[32:35], a[44:47], v[60:63]
    ds_read_b64_tr_b16 a[6:7], v30 offset:1536
    v_mfma_f32_16x16x32_bf16 v[64:67], a[32:35], a[48:51], v[64:67]
    ds_read_b64_tr_b16 a[8:9], v31 offset:0
    v_mfma_f32_16x16x32_bf16 v[68:71], a[32:35], a[52:55], v[68:71]
    ds_read_b64_tr_b16 a[10:11], v31 offset:1536
    v_mfma_f32_16x16x32_bf16 v[72:75], a[36:39], a[40:43], v[72:75]
    v_mfma_f32_16x16x32_bf16 v[76:79], a[36:39], a[44:47], v[76:79]
    v_mfma_f32_16x16x32_bf16 v[80:83], a[36:39], a[48:51], v[80:83]
    v_mfma_f32_16x16x32_bf16 v[84:87], a[36:39], a[52:55], v[84:87]
    s_waitcnt lgkmcnt(0)
    v_mfma_f32_16x16x32_bf16 v[40:43], a[0:3], a[12:15], v[40:43]
    ds_read_b128 a[40:43], v33 offset:0
    ds_read_b128 a[44:47], v33 offset:2048
    v_mfma_f32_16x16x32_bf16 v[44:47], a[0:3], a[16:19], v[44:47]
    ds_read_b128 a[48:51], v33 offset:4096
    v_mfma_f32_16x16x32_bf16 v[48:51], a[0:3], a[20:23], v[48:51]
    ds_read_b128 a[52:55], v33 offset:6144
    v_mfma_f32_16x16x32_bf16 v[52:55], a[0:3], a[24:27], v[52:55]
    ds_read_b64_tr_b16 a[28:29], v29 offset:12288
    v_mfma_f32_16x16x32_bf16 v[56:59], a[4:7], a[12:15], v[56:59]
    ds_read_b64_tr_b16 a[30:31], v29 offset:13824
    ds_read_b64_tr_b16 a[32:33], v30 offset:12288
    v_mfma_f32_16x16x32_bf16 v[60:63], a[4:7], a[16:19], v[60:63]
    ds_read_b64_tr_b16 a[34:35], v30 offset:13824
    v_mfma_f32_16x16x32_bf16 v[64:67], a[4:7], a[20:23], v[64:67]
    ds_read_b64_tr_b16 a[36:37], v31 offset:12288
    v_mfma_f32_16x16x32_bf16 v[68:71], a[4:7], a[24:27], v[68:71]
    ds_read_b64_tr_b16 a[38:39], v31 offset:13824
    v_mfma_f32_16x16x32_bf16 v[72:75], a[8:11], a[12:15], v[72:75]
    v_mfma_f32_16x16x32_bf16 v[76:79], a[8:11], a[16:19], v[76:79]
    v_mfma_f32_16x16x32_bf16 v[80:83], a[8:11], a[20:23], v[80:83]
    v_mfma_f32_16x16x32_bf16 v[84:87], a[8:11], a[24:27], v[84:87]
    s_waitcnt lgkmcnt(0)
    s_barrier
    v_add_u32 v29, 32768, v24
    v_add_u32 v30, 32768, v25
    v_add_u32 v31, 32768, v26
    v_add_u32 v32, 32768, v27
    v_add_u32 v33, 32768, v28
    v_mfma_f32_16x16x32_bf16 v[40:43], a[28:31], a[40:43], v[40:43]
    ds_read_b128 a[12:15], v32 offset:0
    ds_read_b128 a[16:19], v32 offset:2048
    v_mfma_f32_16x16x32_bf16 v[44:47], a[28:31], a[44:47], v[44:47]
    ds_read_b128 a[20:23], v32 offset:4096
    v_mfma_f32_16x16x32_bf16 v[48:51], a[28:31], a[48:51], v[48:51]
    ds_read_b128 a[24:27], v32 offset:6144
    v_mfma_f32_16x16x32_bf16 v[52:55], a[28:31], a[52:55], v[52:55]
    ds_read_b64_tr_b16 a[0:1], v29 offset:0
    v_mfma_f32_16x16x32_bf16 v[56:59], a[32:35], a[40:43], v[56:59]
    ds_read_b64_tr_b16 a[2:3], v29 offset:1536
    ds_read_b64_tr_b16 a[4:5], v30 offset:0
    v_mfma_f32_16x16x32_bf16 v[60:63], a[32:35], a[44:47], v[60:63]
    ds_read_b64_tr_b16 a[6:7], v30 offset:1536
    v_mfma_f32_16x16x32_bf16 v[64:67], a[32:35], a[48:51], v[64:67]
    ds_read_b64_tr_b16 a[8:9], v31 offset:0
    v_mfma_f32_16x16x32_bf16 v[68:71], a[32:35], a[52:55], v[68:71]
    ds_read_b64_tr_b16 a[10:11], v31 offset:1536
    v_mfma_f32_16x16x32_bf16 v[72:75], a[36:39], a[40:43], v[72:75]
    v_mfma_f32_16x16x32_bf16 v[76:79], a[36:39], a[44:47], v[76:79]
    v_mfma_f32_16x16x32_bf16 v[80:83], a[36:39], a[48:51], v[80:83]
    v_mfma_f32_16x16x32_bf16 v[84:87], a[36:39], a[52:55], v[84:87]
    s_waitcnt lgkmcnt(0)
    v_mfma_f32_16x16x32_bf16 v[40:43], a[0:3], a[12:15], v[40:43]
    ds_read_b128 a[40:43], v33 offset:0
    ds_read_b128 a[44:47], v33 offset:2048
    v_mfma_f32_16x16x32_bf16 v[44:47], a[0:3], a[16:19], v[44:47]
    ds_read_b128 a[48:51], v33 offset:4096
    v_mfma_f32_16x16x32_bf16 v[48:51], a[0:3], a[20:23], v[48:51]
    ds_read_b128 a[52:55], v33 offset:6144
    v_mfma_f32_16x16x32_bf16 v[52:55], a[0:3], a[24:27], v[52:55]
    ds_read_b64_tr_b16 a[28:29], v29 offset:12288
    v_mfma_f32_16x16x32_bf16 v[56:59], a[4:7], a[12:15], v[56:59]
    ds_read_b64_tr_b16 a[30:31], v29 offset:13824
    ds_read_b64_tr_b16 a[32:33], v30 offset:12288
    v_mfma_f32_16x16x32_bf16 v[60:63], a[4:7], a[16:19], v[60:63]
    ds_read_b64_tr_b16 a[34:35], v30 offset:13824
    v_mfma_f32_16x16x32_bf16 v[64:67], a[4:7], a[20:23], v[64:67]
    ds_read_b64_tr_b16 a[36:37], v31 offset:12288
    v_mfma_f32_16x16x32_bf16 v[68:71], a[4:7], a[24:27], v[68:71]
    ds_read_b64_tr_b16 a[38:39], v31 offset:13824
    v_mfma_f32_16x16x32_bf16 v[72:75], a[8:11], a[12:15], v[72:75]
    v_mfma_f32_16x16x32_bf16 v[76:79], a[8:11], a[16:19], v[76:79]
    v_mfma_f32_16x16x32_bf16 v[80:83], a[8:11], a[20:23], v[80:83]
    v_mfma_f32_16x16x32_bf16 v[84:87], a[8:11], a[24:27], v[84:87]
    s_waitcnt lgkmcnt(0)
    s_barrier
    v_add_u32 v29, 65536, v24
    v_add_u32 v30, 65536, v25
    v_add_u32 v31, 65536, v26
    v_add_u32 v32, 65536, v27
    v_add_u32 v33, 65536, v28
    v_mfma_f32_16x16x32_bf16 v[40:43], a[28:31], a[40:43], v[40:43]
    ds_read_b128 a[12:15], v32 offset:0
    ds_read_b128 a[16:19], v32 offset:2048
    v_mfma_f32_16x16x32_bf16 v[44:47], a[28:31], a[44:47], v[44:47]
    ds_read_b128 a[20:23], v32 offset:4096
    v_mfma_f32_16x16x32_bf16 v[48:51], a[28:31], a[48:51], v[48:51]
    ds_read_b128 a[24:27], v32 offset:6144
    v_mfma_f32_16x16x32_bf16 v[52:55], a[28:31], a[52:55], v[52:55]
    ds_read_b64_tr_b16 a[0:1], v29 offset:0
    v_mfma_f32_16x16x32_bf16 v[56:59], a[32:35], a[40:43], v[56:59]
    ds_read_b64_tr_b16 a[2:3], v29 offset:1536
    ds_read_b64_tr_b16 a[4:5], v30 offset:0
    v_mfma_f32_16x16x32_bf16 v[60:63], a[32:35], a[44:47], v[60:63]
    ds_read_b64_tr_b16 a[6:7], v30 offset:1536
    v_mfma_f32_16x16x32_bf16 v[64:67], a[32:35], a[48:51], v[64:67]
    ds_read_b64_tr_b16 a[8:9], v31 offset:0
    v_mfma_f32_16x16x32_bf16 v[68:71], a[32:35], a[52:55], v[68:71]
    ds_read_b64_tr_b16 a[10:11], v31 offset:1536
    v_mfma_f32_16x16x32_bf16 v[72:75], a[36:39], a[40:43], v[72:75]
    v_mfma_f32_16x16x32_bf16 v[76:79], a[36:39], a[44:47], v[76:79]
    v_mfma_f32_16x16x32_bf16 v[80:83], a[36:39], a[48:51], v[80:83]
    v_mfma_f32_16x16x32_bf16 v[84:87], a[36:39], a[52:55], v[84:87]
    s_waitcnt lgkmcnt(0)
    v_mfma_f32_16x16x32_bf16 v[40:43], a[0:3], a[12:15], v[40:43]
    ds_read_b128 a[40:43], v33 offset:0
    ds_read_b128 a[44:47], v33 offset:2048
    v_mfma_f32_16x16x32_bf16 v[44:47], a[0:3], a[16:19], v[44:47]
    ds_read_b128 a[48:51], v33 offset:4096
    v_mfma_f32_16x16x32_bf16 v[48:51], a[0:3], a[20:23], v[48:51]
    ds_read_b128 a[52:55], v33 offset:6144
    v_mfma_f32_16x16x32_bf16 v[52:55], a[0:3], a[24:27], v[52:55]
    ds_read_b64_tr_b16 a[28:29], v29 offset:12288
    v_mfma_f32_16x16x32_bf16 v[56:59], a[4:7], a[12:15], v[56:59]
    ds_read_b64_tr_b16 a[30:31], v29 offset:13824
    ds_read_b64_tr_b16 a[32:33], v30 offset:12288
    v_mfma_f32_16x16x32_bf16 v[60:63], a[4:7], a[16:19], v[60:63]
    ds_read_b64_tr_b16 a[34:35], v30 offset:13824
    v_mfma_f32_16x16x32_bf16 v[64:67], a[4:7], a[20:23], v[64:67]
    ds_read_b64_tr_b16 a[36:37], v31 offset:12288
    v_mfma_f32_16x16x32_bf16 v[68:71], a[4:7], a[24:27], v[68:71]
    ds_read_b64_tr_b16 a[38:39], v31 offset:13824
    v_mfma_f32_16x16x32_bf16 v[72:75], a[8:11], a[12:15], v[72:75]
    v_mfma_f32_16x16x32_bf16 v[76:79], a[8:11], a[16:19], v[76:79]
    v_mfma_f32_16x16x32_bf16 v[80:83], a[8:11], a[20:23], v[80:83]
    v_mfma_f32_16x16x32_bf16 v[84:87], a[8:11], a[24:27], v[84:87]
    s_waitcnt lgkmcnt(0)
    s_barrier
    v_add_u32 v29, 0, v24
    v_add_u32 v30, 0, v25
    v_add_u32 v31, 0, v26
    v_add_u32 v32, 0, v27
    v_add_u32 v33, 0, v28
    v_mfma_f32_16x16x32_bf16 v[40:43], a[28:31], a[40:43], v[40:43]
    ds_read_b128 a[12:15], v32 offset:0
    ds_read_b128 a[16:19], v32 offset:2048
    v_mfma_f32_16x16x32_bf16 v[44:47], a[28:31], a[44:47], v[44:47]
    ds_read_b128 a[20:23], v32 offset:4096
    v_mfma_f32_16x16x32_bf16 v[48:51], a[28:31], a[48:51], v[48:51]
    ds_read_b128 a[24:27], v32 offset:6144
    v_mfma_f32_16x16x32_bf16 v[52:55], a[28:31], a[52:55], v[52:55]
    ds_read_b64_tr_b16 a[0:1], v29 offset:0
    v_mfma_f32_16x16x32_bf16 v[56:59], a[32:35], a[40:43], v[56:59]
    ds_read_b64_tr_b16 a[2:3], v29 offset:1536
    ds_read_b64_tr_b16 a[4:5], v30 offset:0
    v_mfma_f32_16x16x32_bf16 v[60:63], a[32:35], a[44:47], v[60:63]
    ds_read_b64_tr_b16 a[6:7], v30 offset:1536
    v_mfma_f32_16x16x32_bf16 v[64:67], a[32:35], a[48:51], v[64:67]
    ds_read_b64_tr_b16 a[8:9], v31 offset:0
    v_mfma_f32_16x16x32_bf16 v[68:71], a[32:35], a[52:55], v[68:71]
    ds_read_b64_tr_b16 a[10:11], v31 offset:1536
    v_mfma_f32_16x16x32_bf16 v[72:75], a[36:39], a[40:43], v[72:75]
    v_mfma_f32_16x16x32_bf16 v[76:79], a[36:39], a[44:47], v[76:79]
    v_mfma_f32_16x16x32_bf16 v[80:83], a[36:39], a[48:51], v[80:83]
    v_mfma_f32_16x16x32_bf16 v[84:87], a[36:39], a[52:55], v[84:87]
    s_waitcnt lgkmcnt(0)
    v_mfma_f32_16x16x32_bf16 v[40:43], a[0:3], a[12:15], v[40:43]
    ds_read_b128 a[40:43], v33 offset:0
    ds_read_b128 a[44:47], v33 offset:2048
    v_mfma_f32_16x16x32_bf16 v[44:47], a[0:3], a[16:19], v[44:47]
    ds_read_b128 a[48:51], v33 offset:4096
    ds_read_b128 a[52:55], v33 offset:6144
    v_mfma_f32_16x16x32_bf16 v[48:51], a[0:3], a[20:23], v[48:51]
    ds_read_b64_tr_b16 a[28:29], v29 offset:12288
    v_mfma_f32_16x16x32_bf16 v[52:55], a[0:3], a[24:27], v[52:55]
    ds_read_b64_tr_b16 a[30:31], v29 offset:13824
    ds_read_b64_tr_b16 a[32:33], v30 offset:12288
    v_mfma_f32_16x16x32_bf16 v[56:59], a[4:7], a[12:15], v[56:59]
    ds_read_b64_tr_b16 a[34:35], v30 offset:13824
    ds_read_b64_tr_b16 a[36:37], v31 offset:12288
    v_mfma_f32_16x16x32_bf16 v[60:63], a[4:7], a[16:19], v[60:63]
    ds_read_b64_tr_b16 a[38:39], v31 offset:13824
    v_mfma_f32_16x16x32_bf16 v[64:67], a[4:7], a[20:23], v[64:67]
    ds_read_b128 a[56:59], v100 offset:0
    ds_read_b128 a[60:63], v100 offset:6144
    v_mfma_f32_16x16x32_bf16 v[68:71], a[4:7], a[24:27], v[68:71]
    ds_read_b128 a[64:67], v100 offset:12288
    ds_read_b128 a[68:71], v100 offset:18432
    v_mfma_f32_16x16x32_bf16 v[72:75], a[8:11], a[12:15], v[72:75]
    ds_read_b128 a[72:75], v101 offset:0
    v_mfma_f32_16x16x32_bf16 v[76:79], a[8:11], a[16:19], v[76:79]
    ds_read_b128 a[76:79], v101 offset:6144
    ds_read_b128 a[80:83], v101 offset:12288
    v_mfma_f32_16x16x32_bf16 v[80:83], a[8:11], a[20:23], v[80:83]
    ds_read_b128 a[84:87], v101 offset:18432
    ds_read_b128 a[88:91], v100 offset:128
    v_mfma_f32_16x16x32_bf16 v[84:87], a[8:11], a[24:27], v[84:87]
    ds_read_b128 a[92:95], v100 offset:6272
    s_waitcnt lgkmcnt(0)
    s_barrier
    v_add_u32 v29, 32768, v24
    v_add_u32 v30, 32768, v25
    v_add_u32 v31, 32768, v26
    v_add_u32 v32, 32768, v27
    v_add_u32 v33, 32768, v28
    v_mfma_f32_16x16x32_bf16 v[40:43], a[28:31], a[40:43], v[40:43]
    ds_read_b128 a[12:15], v32 offset:0
    ds_read_b128 a[16:19], v32 offset:2048
    v_mfma_f32_16x16x32_bf16 v[44:47], a[28:31], a[44:47], v[44:47]
    ds_read_b128 a[20:23], v32 offset:4096
    v_mfma_f32_16x16x32_bf16 v[48:51], a[28:31], a[48:51], v[48:51]
    ds_read_b128 a[24:27], v32 offset:6144
    v_mfma_f32_16x16x32_bf16 v[52:55], a[28:31], a[52:55], v[52:55]
    ds_read_b64_tr_b16 a[0:1], v29 offset:0
    v_mfma_f32_16x16x32_bf16 v[56:59], a[32:35], a[40:43], v[56:59]
    ds_read_b64_tr_b16 a[2:3], v29 offset:1536
    ds_read_b64_tr_b16 a[4:5], v30 offset:0
    v_mfma_f32_16x16x32_bf16 v[60:63], a[32:35], a[44:47], v[60:63]
    ds_read_b64_tr_b16 a[6:7], v30 offset:1536
    v_mfma_f32_16x16x32_bf16 v[64:67], a[32:35], a[48:51], v[64:67]
    ds_read_b64_tr_b16 a[8:9], v31 offset:0
    v_mfma_f32_16x16x32_bf16 v[68:71], a[32:35], a[52:55], v[68:71]
    ds_read_b64_tr_b16 a[10:11], v31 offset:1536
    v_mfma_f32_16x16x32_bf16 v[72:75], a[36:39], a[40:43], v[72:75]
    v_mfma_f32_16x16x32_bf16 v[76:79], a[36:39], a[44:47], v[76:79]
    v_mfma_f32_16x16x32_bf16 v[80:83], a[36:39], a[48:51], v[80:83]
    v_mfma_f32_16x16x32_bf16 v[84:87], a[36:39], a[52:55], v[84:87]
    s_waitcnt lgkmcnt(0)
    v_mfma_f32_16x16x32_bf16 v[40:43], a[0:3], a[12:15], v[40:43]
    ds_read_b128 a[40:43], v33 offset:0
    ds_read_b128 a[44:47], v33 offset:2048
    v_mfma_f32_16x16x32_bf16 v[44:47], a[0:3], a[16:19], v[44:47]
    ds_read_b128 a[48:51], v33 offset:4096
    ds_read_b128 a[52:55], v33 offset:6144
    v_mfma_f32_16x16x32_bf16 v[48:51], a[0:3], a[20:23], v[48:51]
    ds_read_b64_tr_b16 a[28:29], v29 offset:12288
    v_mfma_f32_16x16x32_bf16 v[52:55], a[0:3], a[24:27], v[52:55]
    ds_read_b64_tr_b16 a[30:31], v29 offset:13824
    ds_read_b64_tr_b16 a[32:33], v30 offset:12288
    v_mfma_f32_16x16x32_bf16 v[56:59], a[4:7], a[12:15], v[56:59]
    ds_read_b64_tr_b16 a[34:35], v30 offset:13824
    ds_read_b64_tr_b16 a[36:37], v31 offset:12288
    v_mfma_f32_16x16x32_bf16 v[60:63], a[4:7], a[16:19], v[60:63]
    ds_read_b64_tr_b16 a[38:39], v31 offset:13824
    v_mfma_f32_16x16x32_bf16 v[64:67], a[4:7], a[20:23], v[64:67]
    ds_read_b128 a[96:99], v100 offset:12416
    ds_read_b128 a[100:103], v100 offset:18560
    v_mfma_f32_16x16x32_bf16 v[68:71], a[4:7], a[24:27], v[68:71]
    ds_read_b128 a[104:107], v101 offset:128
    ds_read_b128 a[108:111], v101 offset:6272
    v_mfma_f32_16x16x32_bf16 v[72:75], a[8:11], a[12:15], v[72:75]
    ds_read_b128 a[112:115], v101 offset:12416
    v_mfma_f32_16x16x32_bf16 v[76:79], a[8:11], a[16:19], v[76:79]
    ds_read_b128 a[116:119], v101 offset:18560
    ds_read_b128 a[120:123], v100 offset:256
    v_mfma_f32_16x16x32_bf16 v[80:83], a[8:11], a[20:23], v[80:83]
    ds_read_b128 a[124:127], v100 offset:6400
    ds_read_b128 a[128:131], v100 offset:12544
    v_mfma_f32_16x16x32_bf16 v[84:87], a[8:11], a[24:27], v[84:87]
    ds_read_b128 a[132:135], v100 offset:18688
    s_waitcnt lgkmcnt(0)
    s_barrier
    v_add_u32 v29, 65536, v24
    v_add_u32 v30, 65536, v25
    v_add_u32 v31, 65536, v26
    v_add_u32 v32, 65536, v27
    v_add_u32 v33, 65536, v28
    v_mfma_f32_16x16x32_bf16 v[40:43], a[28:31], a[40:43], v[40:43]
    ds_read_b128 a[12:15], v32 offset:0
    ds_read_b128 a[16:19], v32 offset:2048
    v_mfma_f32_16x16x32_bf16 v[44:47], a[28:31], a[44:47], v[44:47]
    ds_read_b128 a[20:23], v32 offset:4096
    v_mfma_f32_16x16x32_bf16 v[48:51], a[28:31], a[48:51], v[48:51]
    ds_read_b128 a[24:27], v32 offset:6144
    v_mfma_f32_16x16x32_bf16 v[52:55], a[28:31], a[52:55], v[52:55]
    ds_read_b64_tr_b16 a[0:1], v29 offset:0
    v_mfma_f32_16x16x32_bf16 v[56:59], a[32:35], a[40:43], v[56:59]
    ds_read_b64_tr_b16 a[2:3], v29 offset:1536
    ds_read_b64_tr_b16 a[4:5], v30 offset:0
    v_mfma_f32_16x16x32_bf16 v[60:63], a[32:35], a[44:47], v[60:63]
    ds_read_b64_tr_b16 a[6:7], v30 offset:1536
    v_mfma_f32_16x16x32_bf16 v[64:67], a[32:35], a[48:51], v[64:67]
    ds_read_b64_tr_b16 a[8:9], v31 offset:0
    v_mfma_f32_16x16x32_bf16 v[68:71], a[32:35], a[52:55], v[68:71]
    ds_read_b64_tr_b16 a[10:11], v31 offset:1536
    v_mfma_f32_16x16x32_bf16 v[72:75], a[36:39], a[40:43], v[72:75]
    v_mfma_f32_16x16x32_bf16 v[76:79], a[36:39], a[44:47], v[76:79]
    v_mfma_f32_16x16x32_bf16 v[80:83], a[36:39], a[48:51], v[80:83]
    v_mfma_f32_16x16x32_bf16 v[84:87], a[36:39], a[52:55], v[84:87]
    s_waitcnt lgkmcnt(0)
    v_mfma_f32_16x16x32_bf16 v[40:43], a[0:3], a[12:15], v[40:43]
    ds_read_b128 a[40:43], v33 offset:0
    ds_read_b128 a[44:47], v33 offset:2048
    v_mfma_f32_16x16x32_bf16 v[44:47], a[0:3], a[16:19], v[44:47]
    ds_read_b128 a[48:51], v33 offset:4096
    v_mfma_f32_16x16x32_bf16 v[48:51], a[0:3], a[20:23], v[48:51]
    ds_read_b128 a[52:55], v33 offset:6144
    v_mfma_f32_16x16x32_bf16 v[52:55], a[0:3], a[24:27], v[52:55]
    ds_read_b64_tr_b16 a[28:29], v29 offset:12288
    v_mfma_f32_16x16x32_bf16 v[56:59], a[4:7], a[12:15], v[56:59]
    ds_read_b64_tr_b16 a[30:31], v29 offset:13824
    ds_read_b64_tr_b16 a[32:33], v30 offset:12288
    v_mfma_f32_16x16x32_bf16 v[60:63], a[4:7], a[16:19], v[60:63]
    ds_read_b64_tr_b16 a[34:35], v30 offset:13824
    v_mfma_f32_16x16x32_bf16 v[64:67], a[4:7], a[20:23], v[64:67]
    ds_read_b64_tr_b16 a[36:37], v31 offset:12288
    v_mfma_f32_16x16x32_bf16 v[68:71], a[4:7], a[24:27], v[68:71]
    ds_read_b64_tr_b16 a[38:39], v31 offset:13824
    v_mfma_f32_16x16x32_bf16 v[72:75], a[8:11], a[12:15], v[72:75]
    v_mfma_f32_16x16x32_bf16 v[76:79], a[8:11], a[16:19], v[76:79]
    v_mfma_f32_16x16x32_bf16 v[80:83], a[8:11], a[20:23], v[80:83]
    v_mfma_f32_16x16x32_bf16 v[84:87], a[8:11], a[24:27], v[84:87]
    s_waitcnt lgkmcnt(0)
    s_barrier
    v_add_u32 v29, 0, v24
    v_add_u32 v30, 0, v25
    v_add_u32 v31, 0, v26
    v_add_u32 v32, 0, v27
    v_add_u32 v33, 0, v28
    v_mfma_f32_16x16x32_bf16 v[40:43], a[28:31], a[40:43], v[40:43]
    ds_read_b128 a[12:15], v32 offset:0
    ds_read_b128 a[16:19], v32 offset:2048
    v_mfma_f32_16x16x32_bf16 v[44:47], a[28:31], a[44:47], v[44:47]
    ds_read_b128 a[20:23], v32 offset:4096
    v_mfma_f32_16x16x32_bf16 v[48:51], a[28:31], a[48:51], v[48:51]
    ds_read_b128 a[24:27], v32 offset:6144
    v_mfma_f32_16x16x32_bf16 v[52:55], a[28:31], a[52:55], v[52:55]
    ds_read_b64_tr_b16 a[0:1], v29 offset:0
    v_mfma_f32_16x16x32_bf16 v[56:59], a[32:35], a[40:43], v[56:59]
    ds_read_b64_tr_b16 a[2:3], v29 offset:1536
    ds_read_b64_tr_b16 a[4:5], v30 offset:0
    v_mfma_f32_16x16x32_bf16 v[60:63], a[32:35], a[44:47], v[60:63]
    ds_read_b64_tr_b16 a[6:7], v30 offset:1536
    v_mfma_f32_16x16x32_bf16 v[64:67], a[32:35], a[48:51], v[64:67]
    ds_read_b64_tr_b16 a[8:9], v31 offset:0
    v_mfma_f32_16x16x32_bf16 v[68:71], a[32:35], a[52:55], v[68:71]
    ds_read_b64_tr_b16 a[10:11], v31 offset:1536
    v_mfma_f32_16x16x32_bf16 v[72:75], a[36:39], a[40:43], v[72:75]
    v_mfma_f32_16x16x32_bf16 v[76:79], a[36:39], a[44:47], v[76:79]
    v_mfma_f32_16x16x32_bf16 v[80:83], a[36:39], a[48:51], v[80:83]
    v_mfma_f32_16x16x32_bf16 v[84:87], a[36:39], a[52:55], v[84:87]
    s_waitcnt lgkmcnt(0)
    v_mfma_f32_16x16x32_bf16 v[40:43], a[0:3], a[12:15], v[40:43]
    ds_read_b128 a[40:43], v33 offset:0
    ds_read_b128 a[44:47], v33 offset:2048
    v_mfma_f32_16x16x32_bf16 v[44:47], a[0:3], a[16:19], v[44:47]
    ds_read_b128 a[48:51], v33 offset:4096
    v_mfma_f32_16x16x32_bf16 v[48:51], a[0:3], a[20:23], v[48:51]
    ds_read_b128 a[52:55], v33 offset:6144
    v_mfma_f32_16x16x32_bf16 v[52:55], a[0:3], a[24:27], v[52:55]
    ds_read_b64_tr_b16 a[28:29], v29 offset:12288
    v_mfma_f32_16x16x32_bf16 v[56:59], a[4:7], a[12:15], v[56:59]
    ds_read_b64_tr_b16 a[30:31], v29 offset:13824
    ds_read_b64_tr_b16 a[32:33], v30 offset:12288
    v_mfma_f32_16x16x32_bf16 v[60:63], a[4:7], a[16:19], v[60:63]
    ds_read_b64_tr_b16 a[34:35], v30 offset:13824
    v_mfma_f32_16x16x32_bf16 v[64:67], a[4:7], a[20:23], v[64:67]
    ds_read_b64_tr_b16 a[36:37], v31 offset:12288
    v_mfma_f32_16x16x32_bf16 v[68:71], a[4:7], a[24:27], v[68:71]
    ds_read_b64_tr_b16 a[38:39], v31 offset:13824
    v_mfma_f32_16x16x32_bf16 v[72:75], a[8:11], a[12:15], v[72:75]
    v_mfma_f32_16x16x32_bf16 v[76:79], a[8:11], a[16:19], v[76:79]
    v_mfma_f32_16x16x32_bf16 v[80:83], a[8:11], a[20:23], v[80:83]
    v_mfma_f32_16x16x32_bf16 v[84:87], a[8:11], a[24:27], v[84:87]
    s_waitcnt lgkmcnt(0)
    s_mov_b32 s44, 0x3dd53b95
    s_add_u32 s46, s45, s100
    s_barrier
    v_add_u32 v32, 98304, v2
    v_add_u32 v33, 98304, v3
    v_add_u32 v29, 98304, v4
    v_add_u32 v30, 98304, v5
    v_mfma_f32_16x16x32_bf16 v[40:43], a[28:31], a[40:43], v[40:43]
    ds_read_b128 a[0:3], v32 offset:0
    ds_read_b128 a[4:7], v32 offset:2048
    v_mfma_f32_16x16x32_bf16 v[44:47], a[28:31], a[44:47], v[44:47]
    ds_read_b64_tr_b16 a[8:9], v29 offset:0
    v_mfma_f32_16x16x32_bf16 v[48:51], a[28:31], a[48:51], v[48:51]
    ds_read_b64_tr_b16 a[10:11], v29 offset:1280
    ds_read_b64_tr_b16 a[12:13], v30 offset:32
    v_mfma_f32_16x16x32_bf16 v[52:55], a[28:31], a[52:55], v[52:55]
    ds_read_b64_tr_b16 a[14:15], v30 offset:1312
    v_mfma_f32_16x16x32_bf16 v[56:59], a[32:35], a[40:43], v[56:59]
    ds_read_b64_tr_b16 a[16:17], v29 offset:64
    ds_read_b64_tr_b16 a[18:19], v29 offset:1344
    v_mfma_f32_16x16x32_bf16 v[60:63], a[32:35], a[44:47], v[60:63]
    ds_read_b64_tr_b16 a[20:21], v30 offset:96
    v_mfma_f32_16x16x32_bf16 v[64:67], a[32:35], a[48:51], v[64:67]
    ds_read_b64_tr_b16 a[22:23], v30 offset:1376
    ds_read_b64_tr_b16 a[24:25], v29 offset:128
    v_mfma_f32_16x16x32_bf16 v[68:71], a[32:35], a[52:55], v[68:71]
    ds_read_b64_tr_b16 a[26:27], v29 offset:1408
    v_mfma_f32_16x16x32_bf16 v[72:75], a[36:39], a[40:43], v[72:75]
    v_mfma_f32_16x16x32_bf16 v[76:79], a[36:39], a[44:47], v[76:79]
    v_mfma_f32_16x16x32_bf16 v[80:83], a[36:39], a[48:51], v[80:83]
    v_mfma_f32_16x16x32_bf16 v[84:87], a[36:39], a[52:55], v[84:87]
    ds_read_b128 a[28:31], v33 offset:0
    ds_read_b128 a[32:35], v33 offset:2048
    ds_read_b64_tr_b16 a[36:37], v29 offset:10240
    ds_read_b64_tr_b16 a[38:39], v29 offset:11520
    ds_read_b64_tr_b16 a[40:41], v30 offset:10272
    ds_read_b64_tr_b16 a[42:43], v30 offset:11552
    ds_read_b64_tr_b16 a[44:45], v29 offset:10304
    ds_read_b64_tr_b16 a[46:47], v29 offset:11584
    ds_read_b64_tr_b16 a[48:49], v30 offset:10336
    ds_read_b64_tr_b16 a[50:51], v30 offset:11616
    ds_read_b64_tr_b16 a[52:53], v29 offset:10368
    ds_read_b64_tr_b16 a[54:55], v29 offset:11648
    v_cvt_pk_bf16_f32 v14, v84, v85
    v_cvt_pk_bf16_f32 v15, v86, v87
    ds_write_b64 v36, v[14:15] offset:18432
    v_cvt_pk_bf16_f32 v16, v80, v81
    v_cvt_pk_bf16_f32 v17, v82, v83
    ds_write_b64 v36, v[16:17] offset:12288
    s_waitcnt lgkmcnt(12)
    v_mfma_f32_16x16x32_bf16 v[80:83], a[0:3], a[8:11], 0
    v_cvt_pk_bf16_f32 v18, v40, v41
    v_cvt_pk_bf16_f32 v19, v42, v43
    ds_write_b64 v34, v[18:19] offset:0
    v_mfma_f32_16x16x32_bf16 v[100:103], a[4:7], a[8:11], 0
    v_cvt_pk_bf16_f32 v20, v44, v45
    v_cvt_pk_bf16_f32 v21, v46, v47
    ds_write_b64 v34, v[20:21] offset:6144
    v_mfma_f32_16x16x32_bf16 v[84:87], a[0:3], a[12:15], 0
    v_cvt_pk_bf16_f32 v14, v48, v49
    v_cvt_pk_bf16_f32 v15, v50, v51
    ds_write_b64 v34, v[14:15] offset:12288
    v_mfma_f32_16x16x32_bf16 v[104:107], a[4:7], a[12:15], 0
    v_cvt_pk_bf16_f32 v16, v52, v53
    v_cvt_pk_bf16_f32 v17, v54, v55
    ds_write_b64 v34, v[16:17] offset:18432
    v_mfma_f32_16x16x32_bf16 v[88:91], a[0:3], a[16:19], 0
    v_cvt_pk_bf16_f32 v18, v56, v57
    v_cvt_pk_bf16_f32 v19, v58, v59
    ds_write_b64 v35, v[18:19] offset:0
    v_mfma_f32_16x16x32_bf16 v[108:111], a[4:7], a[16:19], 0
    v_cvt_pk_bf16_f32 v20, v60, v61
    v_cvt_pk_bf16_f32 v21, v62, v63
    ds_write_b64 v35, v[20:21] offset:6144
    v_mfma_f32_16x16x32_bf16 v[92:95], a[0:3], a[20:23], 0
    v_cvt_pk_bf16_f32 v14, v64, v65
    v_cvt_pk_bf16_f32 v15, v66, v67
    ds_write_b64 v35, v[14:15] offset:12288
    v_mfma_f32_16x16x32_bf16 v[112:115], a[4:7], a[20:23], 0
    v_cvt_pk_bf16_f32 v16, v68, v69
    v_cvt_pk_bf16_f32 v17, v70, v71
    ds_write_b64 v35, v[16:17] offset:18432
    v_mfma_f32_16x16x32_bf16 v[96:99], a[0:3], a[24:27], 0
    v_cvt_pk_bf16_f32 v18, v72, v73
    v_cvt_pk_bf16_f32 v19, v74, v75
    ds_write_b64 v36, v[18:19] offset:0
    v_mfma_f32_16x16x32_bf16 v[116:119], a[4:7], a[24:27], 0
    v_cvt_pk_bf16_f32 v20, v76, v77
    v_cvt_pk_bf16_f32 v21, v78, v79
    ds_write_b64 v36, v[20:21] offset:6144
    s_waitcnt lgkmcnt(0)
    s_barrier
    v_add_u32 v32, 32768, v2
    v_add_u32 v33, 32768, v3
    v_add_u32 v29, 32768, v4
    v_add_u32 v30, 32768, v5
    s_mul_i32 s62, s98, 6144
    v_add_u32 v14, s62, v37
    v_add_u32 v15, s62, v38
    v_add_u32 v16, 131072, v38
    v_mfma_f32_16x16x32_bf16 v[80:83], a[28:31], a[36:39], v[80:83]
    ds_read_b128 a[0:3], v32 offset:0
    ds_read_b128 a[4:7], v32 offset:2048
    v_mfma_f32_16x16x32_bf16 v[100:103], a[32:35], a[36:39], v[100:103]
    ds_read_b64_tr_b16 a[8:9], v29 offset:0
    ds_read_b64_tr_b16 a[10:11], v29 offset:1280
    v_mfma_f32_16x16x32_bf16 v[84:87], a[28:31], a[40:43], v[84:87]
    ds_read_b64_tr_b16 a[12:13], v30 offset:32
    ds_read_b64_tr_b16 a[14:15], v30 offset:1312
    v_mfma_f32_16x16x32_bf16 v[104:107], a[32:35], a[40:43], v[104:107]
    ds_read_b64_tr_b16 a[16:17], v29 offset:64
    ds_read_b64_tr_b16 a[18:19], v29 offset:1344
    v_mfma_f32_16x16x32_bf16 v[88:91], a[28:31], a[44:47], v[88:91]
    ds_read_b64_tr_b16 a[20:21], v30 offset:96
    ds_read_b64_tr_b16 a[22:23], v30 offset:1376
    v_mfma_f32_16x16x32_bf16 v[108:111], a[32:35], a[44:47], v[108:111]
    ds_read_b64_tr_b16 a[24:25], v29 offset:128
    ds_read_b64_tr_b16 a[26:27], v29 offset:1408
    v_mfma_f32_16x16x32_bf16 v[92:95], a[28:31], a[48:51], v[92:95]
    ds_read_b128 v[40:43], v14 offset:0
    ds_read_b128 v[44:47], v15 offset:0
    v_mfma_f32_16x16x32_bf16 v[112:115], a[32:35], a[48:51], v[112:115]
    ds_read_b128 v[48:51], v14 offset:128
    ds_read_b128 v[52:55], v15 offset:128
    v_mfma_f32_16x16x32_bf16 v[96:99], a[28:31], a[52:55], v[96:99]
    ds_read_b128 v[56:59], v14 offset:256
    ds_read_b128 v[60:63], v15 offset:256
    v_mfma_f32_16x16x32_bf16 v[116:119], a[32:35], a[52:55], v[116:119]
    s_waitcnt lgkmcnt(6)
    v_mfma_f32_16x16x32_bf16 v[80:83], a[0:3], a[8:11], v[80:83]
    ds_read_b128 a[28:31], v33 offset:0
    ds_read_b128 a[32:35], v33 offset:2048
    v_mfma_f32_16x16x32_bf16 v[100:103], a[4:7], a[8:11], v[100:103]
    ds_read_b64_tr_b16 a[36:37], v29 offset:10240
    ds_read_b64_tr_b16 a[38:39], v29 offset:11520
    v_mfma_f32_16x16x32_bf16 v[84:87], a[0:3], a[12:15], v[84:87]
    ds_read_b64_tr_b16 a[40:41], v30 offset:10272
    ds_read_b64_tr_b16 a[42:43], v30 offset:11552
    v_mfma_f32_16x16x32_bf16 v[104:107], a[4:7], a[12:15], v[104:107]
    ds_read_b64_tr_b16 a[44:45], v29 offset:10304
    v_mfma_f32_16x16x32_bf16 v[88:91], a[0:3], a[16:19], v[88:91]
    ds_read_b64_tr_b16 a[46:47], v29 offset:11584
    ds_read_b64_tr_b16 a[48:49], v30 offset:10336
    v_mfma_f32_16x16x32_bf16 v[108:111], a[4:7], a[16:19], v[108:111]
    ds_read_b64_tr_b16 a[50:51], v30 offset:11616
    ds_read_b64_tr_b16 a[52:53], v29 offset:10368
    v_mfma_f32_16x16x32_bf16 v[92:95], a[0:3], a[20:23], v[92:95]
    ds_read_b64_tr_b16 a[54:55], v29 offset:11648
    v_mfma_f32_16x16x32_bf16 v[112:115], a[4:7], a[20:23], v[112:115]
    v_mfma_f32_16x16x32_bf16 v[96:99], a[0:3], a[24:27], v[96:99]
    v_mfma_f32_16x16x32_bf16 v[116:119], a[4:7], a[24:27], v[116:119]
    s_waitcnt lgkmcnt(12)
    v_mfma_f32_16x16x32_bf16 v[64:67], a[56:59], v[40:43], 0
    v_mfma_f32_16x16x32_bf16 v[68:71], a[60:63], v[40:43], 0
    v_mfma_f32_16x16x32_bf16 v[72:75], a[64:67], v[40:43], 0
    v_mfma_f32_16x16x32_bf16 v[76:79], a[68:71], v[40:43], 0
    ds_read_b128 a[56:59], v16 offset:256
    ds_read_b128 a[60:63], v16 offset:6400
    ds_read_b128 a[64:67], v16 offset:12544
    ds_read_b128 a[68:71], v16 offset:18688
    v_mfma_f32_16x16x32_bf16 v[64:67], a[72:75], v[44:47], v[64:67]
    v_mfma_f32_16x16x32_bf16 v[68:71], a[76:79], v[44:47], v[68:71]
    v_mfma_f32_16x16x32_bf16 v[72:75], a[80:83], v[44:47], v[72:75]
    v_mfma_f32_16x16x32_bf16 v[76:79], a[84:87], v[44:47], v[76:79]
    v_mfma_f32_16x16x32_bf16 v[64:67], a[88:91], v[48:51], v[64:67]
    v_mfma_f32_16x16x32_bf16 v[68:71], a[92:95], v[48:51], v[68:71]
    v_mfma_f32_16x16x32_bf16 v[72:75], a[96:99], v[48:51], v[72:75]
    v_mfma_f32_16x16x32_bf16 v[76:79], a[100:103], v[48:51], v[76:79]
    v_mfma_f32_16x16x32_bf16 v[64:67], a[104:107], v[52:55], v[64:67]
    v_mfma_f32_16x16x32_bf16 v[68:71], a[108:111], v[52:55], v[68:71]
    v_mfma_f32_16x16x32_bf16 v[72:75], a[112:115], v[52:55], v[72:75]
    v_mfma_f32_16x16x32_bf16 v[76:79], a[116:119], v[52:55], v[76:79]
    v_mfma_f32_16x16x32_bf16 v[64:67], a[120:123], v[56:59], v[64:67]
    v_mfma_f32_16x16x32_bf16 v[68:71], a[124:127], v[56:59], v[68:71]
    v_mfma_f32_16x16x32_bf16 v[72:75], a[128:131], v[56:59], v[72:75]
    v_mfma_f32_16x16x32_bf16 v[76:79], a[132:135], v[56:59], v[76:79]
    s_waitcnt lgkmcnt(0)
    v_mfma_f32_16x16x32_bf16 v[64:67], a[56:59], v[60:63], v[64:67]
    v_mfma_f32_16x16x32_bf16 v[68:71], a[60:63], v[60:63], v[68:71]
    v_mfma_f32_16x16x32_bf16 v[72:75], a[64:67], v[60:63], v[72:75]
    v_mfma_f32_16x16x32_bf16 v[76:79], a[68:71], v[60:63], v[76:79]
    s_barrier
    v_add_u32 v32, 65536, v2
    v_add_u32 v33, 65536, v3
    v_add_u32 v29, 65536, v4
    v_add_u32 v30, 65536, v5
    v_mfma_f32_16x16x32_bf16 v[80:83], a[28:31], a[36:39], v[80:83]
    ds_read_b128 a[0:3], v32 offset:0
    ds_read_b128 a[4:7], v32 offset:2048
    s_nop 1
    v_max3_f32 v16, v64, v65, v66
    v_max3_f32 v16, v16, v67, v68
    v_max3_f32 v16, v16, v69, v70
    v_max3_f32 v16, v16, v71, v72
    v_mfma_f32_16x16x32_bf16 v[100:103], a[32:35], a[36:39], v[100:103]
    ds_read_b64_tr_b16 a[8:9], v29 offset:0
    ds_read_b64_tr_b16 a[10:11], v29 offset:1280
    v_max3_f32 v16, v16, v73, v74
    v_max3_f32 v16, v16, v75, v76
    v_max3_f32 v16, v16, v77, v78
    v_max_f32 v16, v16, v79
    v_mov_b32 v17, v16
    v_mfma_f32_16x16x32_bf16 v[84:87], a[28:31], a[40:43], v[84:87]
    ds_read_b64_tr_b16 a[12:13], v30 offset:32
    ds_read_b64_tr_b16 a[14:15], v30 offset:1312
    s_nop 1
    v_permlane16_swap_b32 v16, v17
    s_nop 1
    v_max_f32 v16, v16, v17
    v_mov_b32 v17, v16
    v_mfma_f32_16x16x32_bf16 v[104:107], a[32:35], a[40:43], v[104:107]
    ds_read_b64_tr_b16 a[16:17], v29 offset:64
    s_nop 1
    v_permlane32_swap_b32 v16, v17
    s_nop 1
    v_max_f32 v16, v16, v17
    v_mul_f32 v16, s44, v16
    v_mfma_f32_16x16x32_bf16 v[88:91], a[28:31], a[44:47], v[88:91]
    ds_read_b64_tr_b16 a[18:19], v29 offset:1344
    ds_read_b64_tr_b16 a[20:21], v30 offset:96
    v_fma_f32 v64, v64, s44, -v16
    v_fma_f32 v65, v65, s44, -v16
    v_fma_f32 v66, v66, s44, -v16
    v_fma_f32 v67, v67, s44, -v16
    v_fma_f32 v68, v68, s44, -v16
    v_mfma_f32_16x16x32_bf16 v[108:111], a[32:35], a[44:47], v[108:111]
    ds_read_b64_tr_b16 a[22:23], v30 offset:1376
    ds_read_b64_tr_b16 a[24:25], v29 offset:128
    v_fma_f32 v69, v69, s44, -v16
    v_fma_f32 v70, v70, s44, -v16
    v_fma_f32 v71, v71, s44, -v16
    v_fma_f32 v72, v72, s44, -v16
    v_fma_f32 v73, v73, s44, -v16
    v_mfma_f32_16x16x32_bf16 v[92:95], a[28:31], a[48:51], v[92:95]
    ds_read_b64_tr_b16 a[26:27], v29 offset:1408
    v_fma_f32 v74, v74, s44, -v16
    v_fma_f32 v75, v75, s44, -v16
    v_fma_f32 v76, v76, s44, -v16
    v_fma_f32 v77, v77, s44, -v16
    v_fma_f32 v78, v78, s44, -v16
    v_mfma_f32_16x16x32_bf16 v[112:115], a[32:35], a[48:51], v[112:115]
    v_fma_f32 v79, v79, s44, -v16
    v_exp_f32 v64, v64
    v_exp_f32 v65, v65
    v_exp_f32 v66, v66
    v_exp_f32 v67, v67
    v_mfma_f32_16x16x32_bf16 v[96:99], a[28:31], a[52:55], v[96:99]
    v_exp_f32 v68, v68
    v_exp_f32 v69, v69
    v_exp_f32 v70, v70
    v_exp_f32 v71, v71
    v_exp_f32 v72, v72
    v_mfma_f32_16x16x32_bf16 v[116:119], a[32:35], a[52:55], v[116:119]
    v_exp_f32 v73, v73
    v_exp_f32 v74, v74
    v_exp_f32 v75, v75
    v_exp_f32 v76, v76
    v_exp_f32 v77, v77
    s_waitcnt lgkmcnt(0)
    v_mfma_f32_16x16x32_bf16 v[80:83], a[0:3], a[8:11], v[80:83]
    ds_read_b128 a[28:31], v33 offset:0
    ds_read_b128 a[32:35], v33 offset:2048
    v_exp_f32 v78, v78
    v_exp_f32 v79, v79
    s_nop 0
    v_add_f32 v18, v64, v65
    v_add_f32 v19, v66, v67
    v_mfma_f32_16x16x32_bf16 v[100:103], a[4:7], a[8:11], v[100:103]
    ds_read_b64_tr_b16 a[36:37], v29 offset:10240
    ds_read_b64_tr_b16 a[38:39], v29 offset:11520
    v_add_f32 v20, v68, v69
    v_add_f32 v21, v70, v71
    v_add_f32 v18, v18, v72
    v_add_f32 v19, v19, v74
    v_add_f32 v20, v20, v76
    v_mfma_f32_16x16x32_bf16 v[84:87], a[0:3], a[12:15], v[84:87]
    ds_read_b64_tr_b16 a[40:41], v30 offset:10272
    ds_read_b64_tr_b16 a[42:43], v30 offset:11552
    v_add_f32 v21, v21, v78
    v_add_f32 v18, v18, v73
    v_add_f32 v19, v19, v75
    v_add_f32 v20, v20, v77
    v_add_f32 v21, v21, v79
    v_mfma_f32_16x16x32_bf16 v[104:107], a[4:7], a[12:15], v[104:107]
    ds_read_b64_tr_b16 a[44:45], v29 offset:10304
    v_add_f32 v18, v18, v19
    v_add_f32 v20, v20, v21
    v_add_f32 v18, v18, v20
    v_mov_b32 v17, v18
    s_nop 1
    v_mfma_f32_16x16x32_bf16 v[88:91], a[0:3], a[16:19], v[88:91]
    ds_read_b64_tr_b16 a[46:47], v29 offset:11584
    ds_read_b64_tr_b16 a[48:49], v30 offset:10336
    v_permlane16_swap_b32 v18, v17
    s_nop 1
    v_add_f32 v18, v18, v17
    v_mov_b32 v17, v18
    s_nop 1
    v_mfma_f32_16x16x32_bf16 v[108:111], a[4:7], a[16:19], v[108:111]
    ds_read_b64_tr_b16 a[50:51], v30 offset:11616
    ds_read_b64_tr_b16 a[52:53], v29 offset:10368
    v_permlane32_swap_b32 v18, v17
    s_nop 1
    v_add_f32 v18, v18, v17
    v_rcp_f32 v18, v18
    s_nop 0
    v_mfma_f32_16x16x32_bf16 v[92:95], a[0:3], a[20:23], v[92:95]
    ds_read_b64_tr_b16 a[54:55], v29 offset:11648
    v_mul_f32 v64, v64, v18
    v_mul_f32 v65, v65, v18
    v_mul_f32 v66, v66, v18
    v_mul_f32 v67, v67, v18
    v_mul_f32 v68, v68, v18
    v_mfma_f32_16x16x32_bf16 v[112:115], a[4:7], a[20:23], v[112:115]
    v_mul_f32 v69, v69, v18
    v_mul_f32 v70, v70, v18
    v_mul_f32 v71, v71, v18
    v_mul_f32 v72, v72, v18
    v_mul_f32 v73, v73, v18
    v_mfma_f32_16x16x32_bf16 v[96:99], a[0:3], a[24:27], v[96:99]
    v_mul_f32 v74, v74, v18
    v_mul_f32 v75, v75, v18
    v_mul_f32 v76, v76, v18
    v_mul_f32 v77, v77, v18
    v_mul_f32 v78, v78, v18
    v_mfma_f32_16x16x32_bf16 v[116:119], a[4:7], a[24:27], v[116:119]
    v_mul_f32 v79, v79, v18
    v_cvt_pk_bf16_f32 v56, v64, v65
    v_cvt_pk_bf16_f32 v57, v66, v67
    v_cvt_pk_bf16_f32 v58, v68, v69
    v_cvt_pk_bf16_f32 v59, v70, v71
    v_cvt_pk_bf16_f32 v60, v72, v73
    v_cvt_pk_bf16_f32 v61, v74, v75
    v_cvt_pk_bf16_f32 v62, v76, v77
    v_cvt_pk_bf16_f32 v63, v78, v79
    buffer_store_dwordx4 v[56:59], v10, s[28:31], s46 offen offset:0 sc1
    buffer_store_dwordx4 v[60:63], v10, s[28:31], s46 offen offset:1024 sc1
    s_waitcnt lgkmcnt(0)
    s_barrier
    v_add_u32 v32, 98304, v2
    v_add_u32 v33, 98304, v3
    v_add_u32 v29, 98304, v4
    v_add_u32 v30, 98304, v5
    v_mfma_f32_16x16x32_bf16 v[80:83], a[28:31], a[36:39], v[80:83]
    ds_read_b128 a[0:3], v32 offset:0
    ds_read_b128 a[4:7], v32 offset:2048
    v_mfma_f32_16x16x32_bf16 v[100:103], a[32:35], a[36:39], v[100:103]
    ds_read_b64_tr_b16 a[8:9], v29 offset:0
    ds_read_b64_tr_b16 a[10:11], v29 offset:1280
    v_mfma_f32_16x16x32_bf16 v[84:87], a[28:31], a[40:43], v[84:87]
    ds_read_b64_tr_b16 a[12:13], v30 offset:32
    ds_read_b64_tr_b16 a[14:15], v30 offset:1312
    v_mfma_f32_16x16x32_bf16 v[104:107], a[32:35], a[40:43], v[104:107]
    ds_read_b64_tr_b16 a[16:17], v29 offset:64
    v_mfma_f32_16x16x32_bf16 v[88:91], a[28:31], a[44:47], v[88:91]
    ds_read_b64_tr_b16 a[18:19], v29 offset:1344
    ds_read_b64_tr_b16 a[20:21], v30 offset:96
    v_mfma_f32_16x16x32_bf16 v[108:111], a[32:35], a[44:47], v[108:111]
    ds_read_b64_tr_b16 a[22:23], v30 offset:1376
    ds_read_b64_tr_b16 a[24:25], v29 offset:128
    v_mfma_f32_16x16x32_bf16 v[92:95], a[28:31], a[48:51], v[92:95]
    ds_read_b64_tr_b16 a[26:27], v29 offset:1408
    v_mfma_f32_16x16x32_bf16 v[112:115], a[32:35], a[48:51], v[112:115]
    v_mfma_f32_16x16x32_bf16 v[96:99], a[28:31], a[52:55], v[96:99]
    v_mfma_f32_16x16x32_bf16 v[116:119], a[32:35], a[52:55], v[116:119]
    s_waitcnt lgkmcnt(0)
    v_mfma_f32_16x16x32_bf16 v[40:43], a[0:3], a[8:11], 0
    ds_read_b128 a[28:31], v33 offset:0
    ds_read_b128 a[32:35], v33 offset:2048
    s_nop 1
    s_nop 1
    v_mfma_f32_16x16x32_bf16 v[60:63], a[4:7], a[8:11], 0
    ds_read_b64_tr_b16 a[36:37], v29 offset:10240
    ds_read_b64_tr_b16 a[38:39], v29 offset:11520
    s_nop 1
    s_nop 1
    v_mfma_f32_16x16x32_bf16 v[44:47], a[0:3], a[12:15], 0
    ds_read_b64_tr_b16 a[40:41], v30 offset:10272
    ds_read_b64_tr_b16 a[42:43], v30 offset:11552
    v_cvt_pk_bf16_f32 v16, v80, v81
    v_cvt_pk_bf16_f32 v17, v82, v83
    v_mfma_f32_16x16x32_bf16 v[64:67], a[4:7], a[12:15], 0
    ds_read_b64_tr_b16 a[44:45], v29 offset:10304
    v_cvt_pk_bf16_f32 v18, v100, v101
    v_cvt_pk_bf16_f32 v19, v102, v103
    v_mfma_f32_16x16x32_bf16 v[48:51], a[0:3], a[16:19], 0
    ds_read_b64_tr_b16 a[46:47], v29 offset:11584
    ds_read_b64_tr_b16 a[48:49], v30 offset:10336
    v_accvgpr_write_b32 a56, v16
    v_accvgpr_write_b32 a57, v17
    v_mfma_f32_16x16x32_bf16 v[68:71], a[4:7], a[16:19], 0
    ds_read_b64_tr_b16 a[50:51], v30 offset:11616
    ds_read_b64_tr_b16 a[52:53], v29 offset:10368
    v_accvgpr_write_b32 a58, v18
    v_accvgpr_write_b32 a59, v19
    v_mfma_f32_16x16x32_bf16 v[52:55], a[0:3], a[20:23], 0
    ds_read_b64_tr_b16 a[54:55], v29 offset:11648
    v_cvt_pk_bf16_f32 v20, v84, v85
    v_cvt_pk_bf16_f32 v21, v86, v87
    v_mfma_f32_16x16x32_bf16 v[72:75], a[4:7], a[20:23], 0
    v_cvt_pk_bf16_f32 v22, v104, v105
    v_cvt_pk_bf16_f32 v23, v106, v107
    v_mfma_f32_16x16x32_bf16 v[56:59], a[0:3], a[24:27], 0
    v_accvgpr_write_b32 a60, v20
    v_accvgpr_write_b32 a61, v21
    v_mfma_f32_16x16x32_bf16 v[76:79], a[4:7], a[24:27], 0
    v_accvgpr_write_b32 a62, v22
    v_accvgpr_write_b32 a63, v23
    s_waitcnt vmcnt(0)
    s_lshl_b32 s62, s98, 2
    s_add_u32 s62, s62, s53
    v_mov_b32 v14, 0
    v_mov_b32 v15, 1
    s_mov_b64 s[60:61], exec
    s_mov_b64 exec, 1
    buffer_store_dword v15, v14, s[28:31], s62 offen offset:0 sc1
    s_mov_b64 exec, s[60:61]
    s_waitcnt lgkmcnt(0)
    s_barrier
    v_add_u32 v32, 0, v2
    v_add_u32 v33, 0, v3
    v_add_u32 v29, 0, v4
    v_add_u32 v30, 0, v5
    v_mfma_f32_16x16x32_bf16 v[40:43], a[28:31], a[36:39], v[40:43]
    ds_read_b128 a[0:3], v32 offset:0
    ds_read_b128 a[4:7], v32 offset:2048
    v_cvt_pk_bf16_f32 v16, v88, v89
    v_cvt_pk_bf16_f32 v17, v90, v91
    v_mfma_f32_16x16x32_bf16 v[60:63], a[32:35], a[36:39], v[60:63]
    ds_read_b64_tr_b16 a[8:9], v29 offset:0
    ds_read_b64_tr_b16 a[10:11], v29 offset:1280
    v_cvt_pk_bf16_f32 v18, v108, v109
    v_cvt_pk_bf16_f32 v19, v110, v111
    v_mfma_f32_16x16x32_bf16 v[44:47], a[28:31], a[40:43], v[44:47]
    ds_read_b64_tr_b16 a[12:13], v30 offset:32
    ds_read_b64_tr_b16 a[14:15], v30 offset:1312
    v_accvgpr_write_b32 a64, v16
    v_accvgpr_write_b32 a65, v17
    v_mfma_f32_16x16x32_bf16 v[64:67], a[32:35], a[40:43], v[64:67]
    ds_read_b64_tr_b16 a[16:17], v29 offset:64
    v_accvgpr_write_b32 a66, v18
    v_accvgpr_write_b32 a67, v19
    v_mfma_f32_16x16x32_bf16 v[48:51], a[28:31], a[44:47], v[48:51]
    ds_read_b64_tr_b16 a[18:19], v29 offset:1344
    ds_read_b64_tr_b16 a[20:21], v30 offset:96
    v_cvt_pk_bf16_f32 v20, v92, v93
    v_cvt_pk_bf16_f32 v21, v94, v95
    v_mfma_f32_16x16x32_bf16 v[68:71], a[32:35], a[44:47], v[68:71]
    ds_read_b64_tr_b16 a[22:23], v30 offset:1376
    ds_read_b64_tr_b16 a[24:25], v29 offset:128
    v_cvt_pk_bf16_f32 v22, v112, v113
    v_cvt_pk_bf16_f32 v23, v114, v115
    v_mfma_f32_16x16x32_bf16 v[52:55], a[28:31], a[48:51], v[52:55]
    ds_read_b64_tr_b16 a[26:27], v29 offset:1408
    v_accvgpr_write_b32 a68, v20
    v_accvgpr_write_b32 a69, v21
    v_mfma_f32_16x16x32_bf16 v[72:75], a[32:35], a[48:51], v[72:75]
    v_accvgpr_write_b32 a70, v22
    v_accvgpr_write_b32 a71, v23
    v_mfma_f32_16x16x32_bf16 v[56:59], a[28:31], a[52:55], v[56:59]
    v_cvt_pk_bf16_f32 v16, v96, v97
    v_cvt_pk_bf16_f32 v17, v98, v99
    v_mfma_f32_16x16x32_bf16 v[76:79], a[32:35], a[52:55], v[76:79]
    v_cvt_pk_bf16_f32 v18, v116, v117
    v_cvt_pk_bf16_f32 v19, v118, v119
    s_waitcnt lgkmcnt(0)
    v_mfma_f32_16x16x32_bf16 v[40:43], a[0:3], a[8:11], v[40:43]
    ds_read_b128 a[28:31], v33 offset:0
    ds_read_b128 a[32:35], v33 offset:2048
    v_accvgpr_write_b32 a72, v16
    v_accvgpr_write_b32 a73, v17
    v_mfma_f32_16x16x32_bf16 v[60:63], a[4:7], a[8:11], v[60:63]
    ds_read_b64_tr_b16 a[36:37], v29 offset:10240
    ds_read_b64_tr_b16 a[38:39], v29 offset:11520
    v_accvgpr_write_b32 a74, v18
    v_accvgpr_write_b32 a75, v19
    v_mfma_f32_16x16x32_bf16 v[44:47], a[0:3], a[12:15], v[44:47]
    ds_read_b64_tr_b16 a[40:41], v30 offset:10272
    ds_read_b64_tr_b16 a[42:43], v30 offset:11552
    v_mfma_f32_16x16x32_bf16 v[64:67], a[4:7], a[12:15], v[64:67]
    ds_read_b64_tr_b16 a[44:45], v29 offset:10304
    v_mfma_f32_16x16x32_bf16 v[48:51], a[0:3], a[16:19], v[48:51]
    ds_read_b64_tr_b16 a[46:47], v29 offset:11584
    ds_read_b64_tr_b16 a[48:49], v30 offset:10336
    v_mfma_f32_16x16x32_bf16 v[68:71], a[4:7], a[16:19], v[68:71]
    ds_read_b64_tr_b16 a[50:51], v30 offset:11616
    ds_read_b64_tr_b16 a[52:53], v29 offset:10368
    v_mfma_f32_16x16x32_bf16 v[52:55], a[0:3], a[20:23], v[52:55]
    ds_read_b64_tr_b16 a[54:55], v29 offset:11648
    v_mfma_f32_16x16x32_bf16 v[72:75], a[4:7], a[20:23], v[72:75]
    v_mfma_f32_16x16x32_bf16 v[56:59], a[0:3], a[24:27], v[56:59]
    v_mfma_f32_16x16x32_bf16 v[76:79], a[4:7], a[24:27], v[76:79]
    s_waitcnt lgkmcnt(0)
    s_barrier
    v_add_u32 v32, 131072, v2
    v_add_u32 v33, 131072, v3
    v_add_u32 v29, 131072, v4
    v_add_u32 v30, 131072, v5
    v_mfma_f32_16x16x32_bf16 v[40:43], a[28:31], a[36:39], v[40:43]
    ds_read_b128 a[0:3], v32 offset:0
    ds_read_b128 a[4:7], v32 offset:2048
    v_mfma_f32_16x16x32_bf16 v[60:63], a[32:35], a[36:39], v[60:63]
    ds_read_b64_tr_b16 a[8:9], v29 offset:0
    ds_read_b64_tr_b16 a[10:11], v29 offset:1280
    v_mfma_f32_16x16x32_bf16 v[44:47], a[28:31], a[40:43], v[44:47]
    ds_read_b64_tr_b16 a[12:13], v30 offset:32
    ds_read_b64_tr_b16 a[14:15], v30 offset:1312
    v_mfma_f32_16x16x32_bf16 v[64:67], a[32:35], a[40:43], v[64:67]
    ds_read_b64_tr_b16 a[16:17], v29 offset:64
    v_mfma_f32_16x16x32_bf16 v[48:51], a[28:31], a[44:47], v[48:51]
    ds_read_b64_tr_b16 a[18:19], v29 offset:1344
    ds_read_b64_tr_b16 a[20:21], v30 offset:96
    v_mfma_f32_16x16x32_bf16 v[68:71], a[32:35], a[44:47], v[68:71]
    ds_read_b64_tr_b16 a[22:23], v30 offset:1376
    ds_read_b64_tr_b16 a[24:25], v29 offset:128
    v_mfma_f32_16x16x32_bf16 v[52:55], a[28:31], a[48:51], v[52:55]
    ds_read_b64_tr_b16 a[26:27], v29 offset:1408
    v_mfma_f32_16x16x32_bf16 v[72:75], a[32:35], a[48:51], v[72:75]
    v_mfma_f32_16x16x32_bf16 v[56:59], a[28:31], a[52:55], v[56:59]
    v_mfma_f32_16x16x32_bf16 v[76:79], a[32:35], a[52:55], v[76:79]
    s_waitcnt lgkmcnt(0)
    v_mfma_f32_16x16x32_bf16 v[40:43], a[0:3], a[8:11], v[40:43]
    ds_read_b128 a[28:31], v33 offset:0
    ds_read_b128 a[32:35], v33 offset:2048
    v_mfma_f32_16x16x32_bf16 v[60:63], a[4:7], a[8:11], v[60:63]
    ds_read_b64_tr_b16 a[36:37], v29 offset:10240
    ds_read_b64_tr_b16 a[38:39], v29 offset:11520
    v_mfma_f32_16x16x32_bf16 v[44:47], a[0:3], a[12:15], v[44:47]
    ds_read_b64_tr_b16 a[40:41], v30 offset:10272
    ds_read_b64_tr_b16 a[42:43], v30 offset:11552
    v_mfma_f32_16x16x32_bf16 v[64:67], a[4:7], a[12:15], v[64:67]
    ds_read_b64_tr_b16 a[44:45], v29 offset:10304
    v_mfma_f32_16x16x32_bf16 v[48:51], a[0:3], a[16:19], v[48:51]
    ds_read_b64_tr_b16 a[46:47], v29 offset:11584
    ds_read_b64_tr_b16 a[48:49], v30 offset:10336
    v_mfma_f32_16x16x32_bf16 v[68:71], a[4:7], a[16:19], v[68:71]
    ds_read_b64_tr_b16 a[50:51], v30 offset:11616
    ds_read_b64_tr_b16 a[52:53], v29 offset:10368
    v_mfma_f32_16x16x32_bf16 v[52:55], a[0:3], a[20:23], v[52:55]
    ds_read_b64_tr_b16 a[54:55], v29 offset:11648
    v_mfma_f32_16x16x32_bf16 v[72:75], a[4:7], a[20:23], v[72:75]
    v_mfma_f32_16x16x32_bf16 v[56:59], a[0:3], a[24:27], v[56:59]
    v_mfma_f32_16x16x32_bf16 v[76:79], a[4:7], a[24:27], v[76:79]
    s_waitcnt lgkmcnt(0)
    s_barrier
    v_add_u32 v32, 32768, v2
    v_add_u32 v33, 32768, v3
    v_add_u32 v29, 32768, v4
    v_add_u32 v30, 32768, v5
    v_mfma_f32_16x16x32_bf16 v[40:43], a[28:31], a[36:39], v[40:43]
    ds_read_b128 a[0:3], v32 offset:0
    ds_read_b128 a[4:7], v32 offset:2048
    v_mfma_f32_16x16x32_bf16 v[60:63], a[32:35], a[36:39], v[60:63]
    ds_read_b64_tr_b16 a[8:9], v29 offset:0
    ds_read_b64_tr_b16 a[10:11], v29 offset:1280
    v_mfma_f32_16x16x32_bf16 v[44:47], a[28:31], a[40:43], v[44:47]
    ds_read_b64_tr_b16 a[12:13], v30 offset:32
    ds_read_b64_tr_b16 a[14:15], v30 offset:1312
    v_mfma_f32_16x16x32_bf16 v[64:67], a[32:35], a[40:43], v[64:67]
    ds_read_b64_tr_b16 a[16:17], v29 offset:64
    v_mfma_f32_16x16x32_bf16 v[48:51], a[28:31], a[44:47], v[48:51]
    ds_read_b64_tr_b16 a[18:19], v29 offset:1344
    ds_read_b64_tr_b16 a[20:21], v30 offset:96
    v_mfma_f32_16x16x32_bf16 v[68:71], a[32:35], a[44:47], v[68:71]
    ds_read_b64_tr_b16 a[22:23], v30 offset:1376
    ds_read_b64_tr_b16 a[24:25], v29 offset:128
    v_mfma_f32_16x16x32_bf16 v[52:55], a[28:31], a[48:51], v[52:55]
    ds_read_b64_tr_b16 a[26:27], v29 offset:1408
    v_mfma_f32_16x16x32_bf16 v[72:75], a[32:35], a[48:51], v[72:75]
    v_mfma_f32_16x16x32_bf16 v[56:59], a[28:31], a[52:55], v[56:59]
    v_mfma_f32_16x16x32_bf16 v[76:79], a[32:35], a[52:55], v[76:79]
    s_waitcnt lgkmcnt(0)
    v_mfma_f32_16x16x32_bf16 v[80:83], a[0:3], a[8:11], 0
    ds_read_b128 a[28:31], v33 offset:0
    ds_read_b128 a[32:35], v33 offset:2048
    s_nop 1
    s_nop 1
    v_mfma_f32_16x16x32_bf16 v[100:103], a[4:7], a[8:11], 0
    ds_read_b64_tr_b16 a[36:37], v29 offset:10240
    ds_read_b64_tr_b16 a[38:39], v29 offset:11520
    s_nop 1
    s_nop 1
    v_mfma_f32_16x16x32_bf16 v[84:87], a[0:3], a[12:15], 0
    ds_read_b64_tr_b16 a[40:41], v30 offset:10272
    ds_read_b64_tr_b16 a[42:43], v30 offset:11552
    v_cvt_pk_bf16_f32 v16, v40, v41
    v_cvt_pk_bf16_f32 v17, v42, v43
    v_mfma_f32_16x16x32_bf16 v[104:107], a[4:7], a[12:15], 0
    ds_read_b64_tr_b16 a[44:45], v29 offset:10304
    v_cvt_pk_bf16_f32 v18, v60, v61
    v_cvt_pk_bf16_f32 v19, v62, v63
    v_mfma_f32_16x16x32_bf16 v[88:91], a[0:3], a[16:19], 0
    ds_read_b64_tr_b16 a[46:47], v29 offset:11584
    ds_read_b64_tr_b16 a[48:49], v30 offset:10336
    v_accvgpr_write_b32 a76, v16
    v_accvgpr_write_b32 a77, v17
    v_mfma_f32_16x16x32_bf16 v[108:111], a[4:7], a[16:19], 0
    ds_read_b64_tr_b16 a[50:51], v30 offset:11616
    ds_read_b64_tr_b16 a[52:53], v29 offset:10368
    v_accvgpr_write_b32 a78, v18
    v_accvgpr_write_b32 a79, v19
    v_mfma_f32_16x16x32_bf16 v[92:95], a[0:3], a[20:23], 0
    ds_read_b64_tr_b16 a[54:55], v29 offset:11648
    v_cvt_pk_bf16_f32 v20, v44, v45
    v_cvt_pk_bf16_f32 v21, v46, v47
    v_mfma_f32_16x16x32_bf16 v[112:115], a[4:7], a[20:23], 0
    v_cvt_pk_bf16_f32 v22, v64, v65
    v_cvt_pk_bf16_f32 v23, v66, v67
    v_mfma_f32_16x16x32_bf16 v[96:99], a[0:3], a[24:27], 0
    v_accvgpr_write_b32 a80, v20
    v_accvgpr_write_b32 a81, v21
    v_mfma_f32_16x16x32_bf16 v[116:119], a[4:7], a[24:27], 0
    v_accvgpr_write_b32 a82, v22
    v_accvgpr_write_b32 a83, v23
    s_waitcnt lgkmcnt(0)
    s_barrier
    v_add_u32 v32, 65536, v2
    v_add_u32 v33, 65536, v3
    v_add_u32 v29, 65536, v4
    v_add_u32 v30, 65536, v5
    v_mfma_f32_16x16x32_bf16 v[80:83], a[28:31], a[36:39], v[80:83]
    ds_read_b128 a[0:3], v32 offset:0
    ds_read_b128 a[4:7], v32 offset:2048
    v_cvt_pk_bf16_f32 v16, v48, v49
    v_cvt_pk_bf16_f32 v17, v50, v51
    v_mfma_f32_16x16x32_bf16 v[100:103], a[32:35], a[36:39], v[100:103]
    ds_read_b64_tr_b16 a[8:9], v29 offset:0
    ds_read_b64_tr_b16 a[10:11], v29 offset:1280
    v_cvt_pk_bf16_f32 v18, v68, v69
    v_cvt_pk_bf16_f32 v19, v70, v71
    v_mfma_f32_16x16x32_bf16 v[84:87], a[28:31], a[40:43], v[84:87]
    ds_read_b64_tr_b16 a[12:13], v30 offset:32
    ds_read_b64_tr_b16 a[14:15], v30 offset:1312
    v_accvgpr_write_b32 a84, v16
    v_accvgpr_write_b32 a85, v17
    v_mfma_f32_16x16x32_bf16 v[104:107], a[32:35], a[40:43], v[104:107]
    ds_read_b64_tr_b16 a[16:17], v29 offset:64
    v_accvgpr_write_b32 a86, v18
    v_accvgpr_write_b32 a87, v19
    v_mfma_f32_16x16x32_bf16 v[88:91], a[28:31], a[44:47], v[88:91]
    ds_read_b64_tr_b16 a[18:19], v29 offset:1344
    ds_read_b64_tr_b16 a[20:21], v30 offset:96
    v_cvt_pk_bf16_f32 v20, v52, v53
    v_cvt_pk_bf16_f32 v21, v54, v55
    v_mfma_f32_16x16x32_bf16 v[108:111], a[32:35], a[44:47], v[108:111]
    ds_read_b64_tr_b16 a[22:23], v30 offset:1376
    ds_read_b64_tr_b16 a[24:25], v29 offset:128
    v_cvt_pk_bf16_f32 v22, v72, v73
    v_cvt_pk_bf16_f32 v23, v74, v75
    v_mfma_f32_16x16x32_bf16 v[92:95], a[28:31], a[48:51], v[92:95]
    ds_read_b64_tr_b16 a[26:27], v29 offset:1408
    v_accvgpr_write_b32 a88, v20
    v_accvgpr_write_b32 a89, v21
    v_mfma_f32_16x16x32_bf16 v[112:115], a[32:35], a[48:51], v[112:115]
    v_accvgpr_write_b32 a90, v22
    v_accvgpr_write_b32 a91, v23
    v_mfma_f32_16x16x32_bf16 v[96:99], a[28:31], a[52:55], v[96:99]
    v_cvt_pk_bf16_f32 v16, v56, v57
    v_cvt_pk_bf16_f32 v17, v58, v59
    v_mfma_f32_16x16x32_bf16 v[116:119], a[32:35], a[52:55], v[116:119]
    v_cvt_pk_bf16_f32 v18, v76, v77
    v_cvt_pk_bf16_f32 v19, v78, v79
    s_waitcnt lgkmcnt(0)
    v_mfma_f32_16x16x32_bf16 v[80:83], a[0:3], a[8:11], v[80:83]
    ds_read_b128 a[28:31], v33 offset:0
    ds_read_b128 a[32:35], v33 offset:2048
    v_accvgpr_write_b32 a92, v16
    v_accvgpr_write_b32 a93, v17
    v_mfma_f32_16x16x32_bf16 v[100:103], a[4:7], a[8:11], v[100:103]
    ds_read_b64_tr_b16 a[36:37], v29 offset:10240
    ds_read_b64_tr_b16 a[38:39], v29 offset:11520
    v_accvgpr_write_b32 a94, v18
    v_accvgpr_write_b32 a95, v19
    v_mfma_f32_16x16x32_bf16 v[84:87], a[0:3], a[12:15], v[84:87]
    ds_read_b64_tr_b16 a[40:41], v30 offset:10272
    ds_read_b64_tr_b16 a[42:43], v30 offset:11552
    v_mfma_f32_16x16x32_bf16 v[104:107], a[4:7], a[12:15], v[104:107]
    ds_read_b64_tr_b16 a[44:45], v29 offset:10304
    v_mfma_f32_16x16x32_bf16 v[88:91], a[0:3], a[16:19], v[88:91]
    ds_read_b64_tr_b16 a[46:47], v29 offset:11584
    ds_read_b64_tr_b16 a[48:49], v30 offset:10336
    v_mfma_f32_16x16x32_bf16 v[108:111], a[4:7], a[16:19], v[108:111]
    ds_read_b64_tr_b16 a[50:51], v30 offset:11616
    ds_read_b64_tr_b16 a[52:53], v29 offset:10368
    v_mfma_f32_16x16x32_bf16 v[92:95], a[0:3], a[20:23], v[92:95]
    ds_read_b64_tr_b16 a[54:55], v29 offset:11648
    v_mfma_f32_16x16x32_bf16 v[112:115], a[4:7], a[20:23], v[112:115]
    v_mfma_f32_16x16x32_bf16 v[96:99], a[0:3], a[24:27], v[96:99]
    v_mfma_f32_16x16x32_bf16 v[116:119], a[4:7], a[24:27], v[116:119]
    s_waitcnt lgkmcnt(0)
    s_barrier
    v_add_u32 v32, 98304, v2
    v_add_u32 v33, 98304, v3
    v_add_u32 v29, 98304, v4
    v_add_u32 v30, 98304, v5
    v_mfma_f32_16x16x32_bf16 v[80:83], a[28:31], a[36:39], v[80:83]
    ds_read_b128 a[0:3], v32 offset:0
    ds_read_b128 a[4:7], v32 offset:2048
    v_mfma_f32_16x16x32_bf16 v[100:103], a[32:35], a[36:39], v[100:103]
    ds_read_b64_tr_b16 a[8:9], v29 offset:0
    ds_read_b64_tr_b16 a[10:11], v29 offset:1280
    v_mfma_f32_16x16x32_bf16 v[84:87], a[28:31], a[40:43], v[84:87]
    ds_read_b64_tr_b16 a[12:13], v30 offset:32
    ds_read_b64_tr_b16 a[14:15], v30 offset:1312
    v_mfma_f32_16x16x32_bf16 v[104:107], a[32:35], a[40:43], v[104:107]
    ds_read_b64_tr_b16 a[16:17], v29 offset:64
    v_mfma_f32_16x16x32_bf16 v[88:91], a[28:31], a[44:47], v[88:91]
    ds_read_b64_tr_b16 a[18:19], v29 offset:1344
    ds_read_b64_tr_b16 a[20:21], v30 offset:96
    v_mfma_f32_16x16x32_bf16 v[108:111], a[32:35], a[44:47], v[108:111]
    ds_read_b64_tr_b16 a[22:23], v30 offset:1376
    ds_read_b64_tr_b16 a[24:25], v29 offset:128
    v_mfma_f32_16x16x32_bf16 v[92:95], a[28:31], a[48:51], v[92:95]
    ds_read_b64_tr_b16 a[26:27], v29 offset:1408
    v_mfma_f32_16x16x32_bf16 v[112:115], a[32:35], a[48:51], v[112:115]
    v_mfma_f32_16x16x32_bf16 v[96:99], a[28:31], a[52:55], v[96:99]
    v_mfma_f32_16x16x32_bf16 v[116:119], a[32:35], a[52:55], v[116:119]
    s_waitcnt lgkmcnt(0)
    v_mfma_f32_16x16x32_bf16 v[80:83], a[0:3], a[8:11], v[80:83]
    ds_read_b128 a[28:31], v33 offset:0
    ds_read_b128 a[32:35], v33 offset:2048
    v_mfma_f32_16x16x32_bf16 v[100:103], a[4:7], a[8:11], v[100:103]
    ds_read_b64_tr_b16 a[36:37], v29 offset:10240
    ds_read_b64_tr_b16 a[38:39], v29 offset:11520
    v_mfma_f32_16x16x32_bf16 v[84:87], a[0:3], a[12:15], v[84:87]
    ds_read_b64_tr_b16 a[40:41], v30 offset:10272
    ds_read_b64_tr_b16 a[42:43], v30 offset:11552
    v_mfma_f32_16x16x32_bf16 v[104:107], a[4:7], a[12:15], v[104:107]
    ds_read_b64_tr_b16 a[44:45], v29 offset:10304
    v_mfma_f32_16x16x32_bf16 v[88:91], a[0:3], a[16:19], v[88:91]
    ds_read_b64_tr_b16 a[46:47], v29 offset:11584
    ds_read_b64_tr_b16 a[48:49], v30 offset:10336
    v_mfma_f32_16x16x32_bf16 v[108:111], a[4:7], a[16:19], v[108:111]
    ds_read_b64_tr_b16 a[50:51], v30 offset:11616
    ds_read_b64_tr_b16 a[52:53], v29 offset:10368
    v_mfma_f32_16x16x32_bf16 v[92:95], a[0:3], a[20:23], v[92:95]
    ds_read_b64_tr_b16 a[54:55], v29 offset:11648
    v_mfma_f32_16x16x32_bf16 v[112:115], a[4:7], a[20:23], v[112:115]
    v_mfma_f32_16x16x32_bf16 v[96:99], a[0:3], a[24:27], v[96:99]
    v_mfma_f32_16x16x32_bf16 v[116:119], a[4:7], a[24:27], v[116:119]
    s_waitcnt lgkmcnt(0)
    s_barrier
    v_add_u32 v32, 0, v2
    v_add_u32 v33, 0, v3
    v_add_u32 v29, 0, v4
    v_add_u32 v30, 0, v5
    v_mfma_f32_16x16x32_bf16 v[80:83], a[28:31], a[36:39], v[80:83]
    ds_read_b128 a[0:3], v32 offset:0
    ds_read_b128 a[4:7], v32 offset:2048
    v_mfma_f32_16x16x32_bf16 v[100:103], a[32:35], a[36:39], v[100:103]
    ds_read_b64_tr_b16 a[8:9], v29 offset:0
    ds_read_b64_tr_b16 a[10:11], v29 offset:1280
    v_mfma_f32_16x16x32_bf16 v[84:87], a[28:31], a[40:43], v[84:87]
    ds_read_b64_tr_b16 a[12:13], v30 offset:32
    ds_read_b64_tr_b16 a[14:15], v30 offset:1312
    v_mfma_f32_16x16x32_bf16 v[104:107], a[32:35], a[40:43], v[104:107]
    ds_read_b64_tr_b16 a[16:17], v29 offset:64
    v_mfma_f32_16x16x32_bf16 v[88:91], a[28:31], a[44:47], v[88:91]
    ds_read_b64_tr_b16 a[18:19], v29 offset:1344
    ds_read_b64_tr_b16 a[20:21], v30 offset:96
    v_mfma_f32_16x16x32_bf16 v[108:111], a[32:35], a[44:47], v[108:111]
    ds_read_b64_tr_b16 a[22:23], v30 offset:1376
    ds_read_b64_tr_b16 a[24:25], v29 offset:128
    v_mfma_f32_16x16x32_bf16 v[92:95], a[28:31], a[48:51], v[92:95]
    ds_read_b64_tr_b16 a[26:27], v29 offset:1408
    v_mfma_f32_16x16x32_bf16 v[112:115], a[32:35], a[48:51], v[112:115]
    v_mfma_f32_16x16x32_bf16 v[96:99], a[28:31], a[52:55], v[96:99]
    v_mfma_f32_16x16x32_bf16 v[116:119], a[32:35], a[52:55], v[116:119]
    s_waitcnt lgkmcnt(0)
    v_mfma_f32_16x16x32_bf16 v[40:43], a[0:3], a[8:11], 0
    ds_read_b128 a[28:31], v33 offset:0
    ds_read_b128 a[32:35], v33 offset:2048
    s_nop 1
    s_nop 1
    v_mfma_f32_16x16x32_bf16 v[60:63], a[4:7], a[8:11], 0
    ds_read_b64_tr_b16 a[36:37], v29 offset:10240
    ds_read_b64_tr_b16 a[38:39], v29 offset:11520
    s_nop 1
    s_nop 1
    v_mfma_f32_16x16x32_bf16 v[44:47], a[0:3], a[12:15], 0
    ds_read_b64_tr_b16 a[40:41], v30 offset:10272
    ds_read_b64_tr_b16 a[42:43], v30 offset:11552
    v_cvt_pk_bf16_f32 v16, v80, v81
    v_cvt_pk_bf16_f32 v17, v82, v83
    v_mfma_f32_16x16x32_bf16 v[64:67], a[4:7], a[12:15], 0
    ds_read_b64_tr_b16 a[44:45], v29 offset:10304
    v_cvt_pk_bf16_f32 v18, v100, v101
    v_cvt_pk_bf16_f32 v19, v102, v103
    v_mfma_f32_16x16x32_bf16 v[48:51], a[0:3], a[16:19], 0
    ds_read_b64_tr_b16 a[46:47], v29 offset:11584
    ds_read_b64_tr_b16 a[48:49], v30 offset:10336
    v_accvgpr_write_b32 a96, v16
    v_accvgpr_write_b32 a97, v17
    v_mfma_f32_16x16x32_bf16 v[68:71], a[4:7], a[16:19], 0
    ds_read_b64_tr_b16 a[50:51], v30 offset:11616
    ds_read_b64_tr_b16 a[52:53], v29 offset:10368
    v_accvgpr_write_b32 a98, v18
    v_accvgpr_write_b32 a99, v19
    v_mfma_f32_16x16x32_bf16 v[52:55], a[0:3], a[20:23], 0
    ds_read_b64_tr_b16 a[54:55], v29 offset:11648
    v_cvt_pk_bf16_f32 v20, v84, v85
    v_cvt_pk_bf16_f32 v21, v86, v87
    v_mfma_f32_16x16x32_bf16 v[72:75], a[4:7], a[20:23], 0
    v_cvt_pk_bf16_f32 v22, v104, v105
    v_cvt_pk_bf16_f32 v23, v106, v107
    v_mfma_f32_16x16x32_bf16 v[56:59], a[0:3], a[24:27], 0
    v_accvgpr_write_b32 a100, v20
    v_accvgpr_write_b32 a101, v21
    v_mfma_f32_16x16x32_bf16 v[76:79], a[4:7], a[24:27], 0
    v_accvgpr_write_b32 a102, v22
    v_accvgpr_write_b32 a103, v23
    s_waitcnt lgkmcnt(0)
    s_barrier
    v_add_u32 v32, 131072, v2
    v_add_u32 v33, 131072, v3
    v_add_u32 v29, 131072, v4
    v_add_u32 v30, 131072, v5
    v_mfma_f32_16x16x32_bf16 v[40:43], a[28:31], a[36:39], v[40:43]
    ds_read_b128 a[0:3], v32 offset:0
    ds_read_b128 a[4:7], v32 offset:2048
    v_cvt_pk_bf16_f32 v16, v88, v89
    v_cvt_pk_bf16_f32 v17, v90, v91
    v_mfma_f32_16x16x32_bf16 v[60:63], a[32:35], a[36:39], v[60:63]
    ds_read_b64_tr_b16 a[8:9], v29 offset:0
    ds_read_b64_tr_b16 a[10:11], v29 offset:1280
    v_cvt_pk_bf16_f32 v18, v108, v109
    v_cvt_pk_bf16_f32 v19, v110, v111
    v_mfma_f32_16x16x32_bf16 v[44:47], a[28:31], a[40:43], v[44:47]
    ds_read_b64_tr_b16 a[12:13], v30 offset:32
    ds_read_b64_tr_b16 a[14:15], v30 offset:1312
    v_accvgpr_write_b32 a104, v16
    v_accvgpr_write_b32 a105, v17
    v_mfma_f32_16x16x32_bf16 v[64:67], a[32:35], a[40:43], v[64:67]
    ds_read_b64_tr_b16 a[16:17], v29 offset:64
    v_accvgpr_write_b32 a106, v18
    v_accvgpr_write_b32 a107, v19
    v_mfma_f32_16x16x32_bf16 v[48:51], a[28:31], a[44:47], v[48:51]
    ds_read_b64_tr_b16 a[18:19], v29 offset:1344
    ds_read_b64_tr_b16 a[20:21], v30 offset:96
    v_cvt_pk_bf16_f32 v20, v92, v93
    v_cvt_pk_bf16_f32 v21, v94, v95
    v_mfma_f32_16x16x32_bf16 v[68:71], a[32:35], a[44:47], v[68:71]
    ds_read_b64_tr_b16 a[22:23], v30 offset:1376
    ds_read_b64_tr_b16 a[24:25], v29 offset:128
    v_cvt_pk_bf16_f32 v22, v112, v113
    v_cvt_pk_bf16_f32 v23, v114, v115
    v_mfma_f32_16x16x32_bf16 v[52:55], a[28:31], a[48:51], v[52:55]
    ds_read_b64_tr_b16 a[26:27], v29 offset:1408
    v_accvgpr_write_b32 a108, v20
    v_accvgpr_write_b32 a109, v21
    v_mfma_f32_16x16x32_bf16 v[72:75], a[32:35], a[48:51], v[72:75]
    v_accvgpr_write_b32 a110, v22
    v_accvgpr_write_b32 a111, v23
    v_mfma_f32_16x16x32_bf16 v[56:59], a[28:31], a[52:55], v[56:59]
    v_cvt_pk_bf16_f32 v16, v96, v97
    v_cvt_pk_bf16_f32 v17, v98, v99
    v_mfma_f32_16x16x32_bf16 v[76:79], a[32:35], a[52:55], v[76:79]
    v_cvt_pk_bf16_f32 v18, v116, v117
    v_cvt_pk_bf16_f32 v19, v118, v119
    s_waitcnt lgkmcnt(0)
    v_mfma_f32_16x16x32_bf16 v[40:43], a[0:3], a[8:11], v[40:43]
    ds_read_b128 a[28:31], v33 offset:0
    ds_read_b128 a[32:35], v33 offset:2048
    v_accvgpr_write_b32 a112, v16
    v_accvgpr_write_b32 a113, v17
    v_mfma_f32_16x16x32_bf16 v[60:63], a[4:7], a[8:11], v[60:63]
    ds_read_b64_tr_b16 a[36:37], v29 offset:10240
    ds_read_b64_tr_b16 a[38:39], v29 offset:11520
    v_accvgpr_write_b32 a114, v18
    v_accvgpr_write_b32 a115, v19
    v_mfma_f32_16x16x32_bf16 v[44:47], a[0:3], a[12:15], v[44:47]
    ds_read_b64_tr_b16 a[40:41], v30 offset:10272
    ds_read_b64_tr_b16 a[42:43], v30 offset:11552
    v_mfma_f32_16x16x32_bf16 v[64:67], a[4:7], a[12:15], v[64:67]
    ds_read_b64_tr_b16 a[44:45], v29 offset:10304
    v_mfma_f32_16x16x32_bf16 v[48:51], a[0:3], a[16:19], v[48:51]
    ds_read_b64_tr_b16 a[46:47], v29 offset:11584
    ds_read_b64_tr_b16 a[48:49], v30 offset:10336
    v_mfma_f32_16x16x32_bf16 v[68:71], a[4:7], a[16:19], v[68:71]
    ds_read_b64_tr_b16 a[50:51], v30 offset:11616
    ds_read_b64_tr_b16 a[52:53], v29 offset:10368
    v_mfma_f32_16x16x32_bf16 v[52:55], a[0:3], a[20:23], v[52:55]
    ds_read_b64_tr_b16 a[54:55], v29 offset:11648
    v_mfma_f32_16x16x32_bf16 v[72:75], a[4:7], a[20:23], v[72:75]
    v_mfma_f32_16x16x32_bf16 v[56:59], a[0:3], a[24:27], v[56:59]
    v_mfma_f32_16x16x32_bf16 v[76:79], a[4:7], a[24:27], v[76:79]
    s_waitcnt lgkmcnt(0)
    s_barrier
    v_add_u32 v32, 32768, v2
    v_add_u32 v33, 32768, v3
    v_add_u32 v29, 32768, v4
    v_add_u32 v30, 32768, v5
    v_mfma_f32_16x16x32_bf16 v[40:43], a[28:31], a[36:39], v[40:43]
    ds_read_b128 a[0:3], v32 offset:0
    ds_read_b128 a[4:7], v32 offset:2048
    v_mfma_f32_16x16x32_bf16 v[60:63], a[32:35], a[36:39], v[60:63]
    ds_read_b64_tr_b16 a[8:9], v29 offset:0
    ds_read_b64_tr_b16 a[10:11], v29 offset:1280
    v_mfma_f32_16x16x32_bf16 v[44:47], a[28:31], a[40:43], v[44:47]
    ds_read_b64_tr_b16 a[12:13], v30 offset:32
    ds_read_b64_tr_b16 a[14:15], v30 offset:1312
    v_mfma_f32_16x16x32_bf16 v[64:67], a[32:35], a[40:43], v[64:67]
    ds_read_b64_tr_b16 a[16:17], v29 offset:64
    v_mfma_f32_16x16x32_bf16 v[48:51], a[28:31], a[44:47], v[48:51]
    ds_read_b64_tr_b16 a[18:19], v29 offset:1344
    ds_read_b64_tr_b16 a[20:21], v30 offset:96
    v_mfma_f32_16x16x32_bf16 v[68:71], a[32:35], a[44:47], v[68:71]
    ds_read_b64_tr_b16 a[22:23], v30 offset:1376
    ds_read_b64_tr_b16 a[24:25], v29 offset:128
    v_mfma_f32_16x16x32_bf16 v[52:55], a[28:31], a[48:51], v[52:55]
    ds_read_b64_tr_b16 a[26:27], v29 offset:1408
    v_mfma_f32_16x16x32_bf16 v[72:75], a[32:35], a[48:51], v[72:75]
    v_mfma_f32_16x16x32_bf16 v[56:59], a[28:31], a[52:55], v[56:59]
    v_mfma_f32_16x16x32_bf16 v[76:79], a[32:35], a[52:55], v[76:79]
    s_waitcnt lgkmcnt(0)
    v_mfma_f32_16x16x32_bf16 v[40:43], a[0:3], a[8:11], v[40:43]
    ds_read_b128 a[28:31], v33 offset:0
    ds_read_b128 a[32:35], v33 offset:2048
    v_mfma_f32_16x16x32_bf16 v[60:63], a[4:7], a[8:11], v[60:63]
    ds_read_b64_tr_b16 a[36:37], v29 offset:10240
    ds_read_b64_tr_b16 a[38:39], v29 offset:11520
    v_mfma_f32_16x16x32_bf16 v[44:47], a[0:3], a[12:15], v[44:47]
    ds_read_b64_tr_b16 a[40:41], v30 offset:10272
    ds_read_b64_tr_b16 a[42:43], v30 offset:11552
    v_mfma_f32_16x16x32_bf16 v[64:67], a[4:7], a[12:15], v[64:67]
    ds_read_b64_tr_b16 a[44:45], v29 offset:10304
    v_mfma_f32_16x16x32_bf16 v[48:51], a[0:3], a[16:19], v[48:51]
    ds_read_b64_tr_b16 a[46:47], v29 offset:11584
    ds_read_b64_tr_b16 a[48:49], v30 offset:10336
    v_mfma_f32_16x16x32_bf16 v[68:71], a[4:7], a[16:19], v[68:71]
    ds_read_b64_tr_b16 a[50:51], v30 offset:11616
    ds_read_b64_tr_b16 a[52:53], v29 offset:10368
    v_mfma_f32_16x16x32_bf16 v[52:55], a[0:3], a[20:23], v[52:55]
    ds_read_b64_tr_b16 a[54:55], v29 offset:11648
    v_mfma_f32_16x16x32_bf16 v[72:75], a[4:7], a[20:23], v[72:75]
    v_mfma_f32_16x16x32_bf16 v[56:59], a[0:3], a[24:27], v[56:59]
    v_mfma_f32_16x16x32_bf16 v[76:79], a[4:7], a[24:27], v[76:79]
    s_waitcnt lgkmcnt(0)
    s_barrier
    v_mfma_f32_16x16x32_bf16 v[40:43], a[28:31], a[36:39], v[40:43]
    ds_read_b128 a[0:3], v6 offset:0
    v_mfma_f32_16x16x32_bf16 v[60:63], a[32:35], a[36:39], v[60:63]
    ds_read_b128 a[4:7], v6 offset:2048
    v_mfma_f32_16x16x32_bf16 v[44:47], a[28:31], a[40:43], v[44:47]
    ds_read_b128 a[8:11], v6 offset:8192
    v_mfma_f32_16x16x32_bf16 v[64:67], a[32:35], a[40:43], v[64:67]
    ds_read_b128 a[12:15], v6 offset:10240
    v_mfma_f32_16x16x32_bf16 v[48:51], a[28:31], a[44:47], v[48:51]
    ds_read_b128 a[16:19], v6 offset:16384
    v_mfma_f32_16x16x32_bf16 v[68:71], a[32:35], a[44:47], v[68:71]
    ds_read_b128 a[20:23], v6 offset:18432
    v_mfma_f32_16x16x32_bf16 v[52:55], a[28:31], a[48:51], v[52:55]
    v_mfma_f32_16x16x32_bf16 v[72:75], a[32:35], a[48:51], v[72:75]
    v_mfma_f32_16x16x32_bf16 v[56:59], a[28:31], a[52:55], v[56:59]
    v_mfma_f32_16x16x32_bf16 v[76:79], a[32:35], a[52:55], v[76:79]
    s_waitcnt lgkmcnt(4)
    v_mfma_f32_16x16x32_bf16 v[80:83], a[56:59], a[0:3], 0
    ds_read_b128 a[24:27], v6 offset:24576
    s_nop 1
    s_nop 1
    v_mfma_f32_16x16x32_bf16 v[88:91], a[60:63], a[0:3], 0
    ds_read_b128 a[28:31], v6 offset:26624
    s_nop 1
    s_nop 1
    v_mfma_f32_16x16x32_bf16 v[96:99], a[64:67], a[0:3], 0
    ds_read_b128 a[32:35], v0 offset:0
    v_cvt_pk_bf16_f32 v16, v40, v41
    v_cvt_pk_bf16_f32 v17, v42, v43
    v_mfma_f32_16x16x32_bf16 v[104:107], a[68:71], a[0:3], 0
    ds_read_b128 a[36:39], v0 offset:2048
    v_cvt_pk_bf16_f32 v18, v60, v61
    v_cvt_pk_bf16_f32 v19, v62, v63
    v_mfma_f32_16x16x32_bf16 v[112:115], a[72:75], a[0:3], 0
    v_accvgpr_write_b32 a116, v16
    v_accvgpr_write_b32 a117, v17
    v_mfma_f32_16x16x32_bf16 v[84:87], a[56:59], a[4:7], 0
    v_accvgpr_write_b32 a118, v18
    v_accvgpr_write_b32 a119, v19
    v_mfma_f32_16x16x32_bf16 v[92:95], a[60:63], a[4:7], 0
    v_cvt_pk_bf16_f32 v20, v44, v45
    v_cvt_pk_bf16_f32 v21, v46, v47
    v_mfma_f32_16x16x32_bf16 v[100:103], a[64:67], a[4:7], 0
    v_cvt_pk_bf16_f32 v22, v64, v65
    v_cvt_pk_bf16_f32 v23, v66, v67
    v_mfma_f32_16x16x32_bf16 v[108:111], a[68:71], a[4:7], 0
    v_accvgpr_write_b32 a120, v20
    v_accvgpr_write_b32 a121, v21
    v_mfma_f32_16x16x32_bf16 v[116:119], a[72:75], a[4:7], 0
    v_accvgpr_write_b32 a122, v22
    v_accvgpr_write_b32 a123, v23
    s_waitcnt lgkmcnt(6)
    v_mfma_f32_16x16x32_bf16 v[80:83], a[76:79], a[8:11], v[80:83]
    ds_read_b128 a[40:43], v0 offset:8192
    v_cvt_pk_bf16_f32 v16, v48, v49
    v_cvt_pk_bf16_f32 v17, v50, v51
    v_mfma_f32_16x16x32_bf16 v[88:91], a[80:83], a[8:11], v[88:91]
    ds_read_b128 a[44:47], v0 offset:10240
    v_cvt_pk_bf16_f32 v18, v68, v69
    v_cvt_pk_bf16_f32 v19, v70, v71
    v_mfma_f32_16x16x32_bf16 v[96:99], a[84:87], a[8:11], v[96:99]
    ds_read_b128 a[48:51], v0 offset:16384
    v_accvgpr_write_b32 a124, v16
    v_accvgpr_write_b32 a125, v17
    v_mfma_f32_16x16x32_bf16 v[104:107], a[88:91], a[8:11], v[104:107]
    ds_read_b128 a[52:55], v0 offset:18432
    v_accvgpr_write_b32 a126, v18
    v_accvgpr_write_b32 a127, v19
    v_mfma_f32_16x16x32_bf16 v[112:115], a[92:95], a[8:11], v[112:115]
    v_cvt_pk_bf16_f32 v20, v52, v53
    v_cvt_pk_bf16_f32 v21, v54, v55
    v_mfma_f32_16x16x32_bf16 v[84:87], a[76:79], a[12:15], v[84:87]
    v_cvt_pk_bf16_f32 v22, v72, v73
    v_cvt_pk_bf16_f32 v23, v74, v75
    v_mfma_f32_16x16x32_bf16 v[92:95], a[80:83], a[12:15], v[92:95]
    v_accvgpr_write_b32 a128, v20
    v_accvgpr_write_b32 a129, v21
    v_mfma_f32_16x16x32_bf16 v[100:103], a[84:87], a[12:15], v[100:103]
    v_accvgpr_write_b32 a130, v22
    v_accvgpr_write_b32 a131, v23
    v_mfma_f32_16x16x32_bf16 v[108:111], a[88:91], a[12:15], v[108:111]
    v_cvt_pk_bf16_f32 v16, v56, v57
    v_cvt_pk_bf16_f32 v17, v58, v59
    v_mfma_f32_16x16x32_bf16 v[116:119], a[92:95], a[12:15], v[116:119]
    v_cvt_pk_bf16_f32 v18, v76, v77
    v_cvt_pk_bf16_f32 v19, v78, v79
    s_waitcnt lgkmcnt(8)
    v_mfma_f32_16x16x32_bf16 v[80:83], a[96:99], a[16:19], v[80:83]
    v_accvgpr_write_b32 a132, v16
    v_accvgpr_write_b32 a133, v17
    v_mfma_f32_16x16x32_bf16 v[88:91], a[100:103], a[16:19], v[88:91]
    v_accvgpr_write_b32 a134, v18
    v_accvgpr_write_b32 a135, v19
    v_mfma_f32_16x16x32_bf16 v[96:99], a[104:107], a[16:19], v[96:99]
    v_mfma_f32_16x16x32_bf16 v[104:107], a[108:111], a[16:19], v[104:107]
    v_mfma_f32_16x16x32_bf16 v[112:115], a[112:115], a[16:19], v[112:115]
    v_mfma_f32_16x16x32_bf16 v[84:87], a[96:99], a[20:23], v[84:87]
    v_mfma_f32_16x16x32_bf16 v[92:95], a[100:103], a[20:23], v[92:95]
    v_mfma_f32_16x16x32_bf16 v[100:103], a[104:107], a[20:23], v[100:103]
    v_mfma_f32_16x16x32_bf16 v[108:111], a[108:111], a[20:23], v[108:111]
    v_mfma_f32_16x16x32_bf16 v[116:119], a[112:115], a[20:23], v[116:119]
    s_waitcnt lgkmcnt(6)
    s_nop 1
    v_mfma_f32_16x16x32_bf16 v[80:83], a[116:119], a[24:27], v[80:83]
    ds_read_b128 a[0:3], v0 offset:24576
    v_mfma_f32_16x16x32_bf16 v[88:91], a[120:123], a[24:27], v[88:91]
    v_mfma_f32_16x16x32_bf16 v[96:99], a[124:127], a[24:27], v[96:99]
    v_mfma_f32_16x16x32_bf16 v[104:107], a[128:131], a[24:27], v[104:107]
    ds_read_b128 a[4:7], v0 offset:26624
    v_mfma_f32_16x16x32_bf16 v[112:115], a[132:135], a[24:27], v[112:115]
    v_mfma_f32_16x16x32_bf16 v[84:87], a[116:119], a[28:31], v[84:87]
    v_mfma_f32_16x16x32_bf16 v[92:95], a[120:123], a[28:31], v[92:95]
    v_mfma_f32_16x16x32_bf16 v[100:103], a[124:127], a[28:31], v[100:103]
    v_mfma_f32_16x16x32_bf16 v[108:111], a[128:131], a[28:31], v[108:111]
    v_mfma_f32_16x16x32_bf16 v[116:119], a[132:135], a[28:31], v[116:119]
    s_waitcnt lgkmcnt(6)
    v_mfma_f32_16x16x32_bf16 v[40:43], a[56:59], a[32:35], 0
    v_mfma_f32_16x16x32_bf16 v[48:51], a[60:63], a[32:35], 0
    v_mfma_f32_16x16x32_bf16 v[56:59], a[64:67], a[32:35], 0
    v_mfma_f32_16x16x32_bf16 v[64:67], a[68:71], a[32:35], 0
    v_mfma_f32_16x16x32_bf16 v[72:75], a[72:75], a[32:35], 0
    v_mfma_f32_16x16x32_bf16 v[44:47], a[56:59], a[36:39], 0
    v_mfma_f32_16x16x32_bf16 v[52:55], a[60:63], a[36:39], 0
    v_mfma_f32_16x16x32_bf16 v[60:63], a[64:67], a[36:39], 0
    v_mfma_f32_16x16x32_bf16 v[68:71], a[68:71], a[36:39], 0
    v_mfma_f32_16x16x32_bf16 v[76:79], a[72:75], a[36:39], 0
    s_waitcnt lgkmcnt(4)
    v_mfma_f32_16x16x32_bf16 v[40:43], a[76:79], a[40:43], v[40:43]
    ds_write_b128 v7, v[80:83] offset:0
    v_mfma_f32_16x16x32_bf16 v[48:51], a[80:83], a[40:43], v[48:51]
    v_mfma_f32_16x16x32_bf16 v[56:59], a[84:87], a[40:43], v[56:59]
    ds_write_b128 v7, v[84:87] offset:1024
    v_mfma_f32_16x16x32_bf16 v[64:67], a[88:91], a[40:43], v[64:67]
    v_mfma_f32_16x16x32_bf16 v[72:75], a[92:95], a[40:43], v[72:75]
    ds_write_b128 v7, v[88:91] offset:2048
    v_mfma_f32_16x16x32_bf16 v[44:47], a[76:79], a[44:47], v[44:47]
    v_mfma_f32_16x16x32_bf16 v[52:55], a[80:83], a[44:47], v[52:55]
    ds_write_b128 v7, v[92:95] offset:3072
    v_mfma_f32_16x16x32_bf16 v[60:63], a[84:87], a[44:47], v[60:63]
    v_mfma_f32_16x16x32_bf16 v[68:71], a[88:91], a[44:47], v[68:71]
    ds_write_b128 v7, v[96:99] offset:4096
    v_mfma_f32_16x16x32_bf16 v[76:79], a[92:95], a[44:47], v[76:79]
    s_waitcnt lgkmcnt(7)
    v_mfma_f32_16x16x32_bf16 v[40:43], a[96:99], a[48:51], v[40:43]
    ds_write_b128 v7, v[100:103] offset:5120
    v_mfma_f32_16x16x32_bf16 v[48:51], a[100:103], a[48:51], v[48:51]
    v_mfma_f32_16x16x32_bf16 v[56:59], a[104:107], a[48:51], v[56:59]
    ds_write_b128 v7, v[104:107] offset:6144
    v_mfma_f32_16x16x32_bf16 v[64:67], a[108:111], a[48:51], v[64:67]
    v_mfma_f32_16x16x32_bf16 v[72:75], a[112:115], a[48:51], v[72:75]
    ds_write_b128 v7, v[108:111] offset:7168
    v_mfma_f32_16x16x32_bf16 v[44:47], a[96:99], a[52:55], v[44:47]
    v_mfma_f32_16x16x32_bf16 v[52:55], a[100:103], a[52:55], v[52:55]
    ds_write_b128 v7, v[112:115] offset:8192
    v_mfma_f32_16x16x32_bf16 v[60:63], a[104:107], a[52:55], v[60:63]
    v_mfma_f32_16x16x32_bf16 v[68:71], a[108:111], a[52:55], v[68:71]
    ds_write_b128 v7, v[116:119] offset:9216
    v_mfma_f32_16x16x32_bf16 v[76:79], a[112:115], a[52:55], v[76:79]
    s_waitcnt lgkmcnt(10)
    v_mfma_f32_16x16x32_bf16 v[40:43], a[116:119], a[0:3], v[40:43]
    v_mfma_f32_16x16x32_bf16 v[48:51], a[120:123], a[0:3], v[48:51]
    v_mfma_f32_16x16x32_bf16 v[56:59], a[124:127], a[0:3], v[56:59]
    v_mfma_f32_16x16x32_bf16 v[64:67], a[128:131], a[0:3], v[64:67]
    v_mfma_f32_16x16x32_bf16 v[72:75], a[132:135], a[0:3], v[72:75]
    v_mfma_f32_16x16x32_bf16 v[44:47], a[116:119], a[4:7], v[44:47]
    v_mfma_f32_16x16x32_bf16 v[52:55], a[120:123], a[4:7], v[52:55]
    v_mfma_f32_16x16x32_bf16 v[60:63], a[124:127], a[4:7], v[60:63]
    v_mfma_f32_16x16x32_bf16 v[68:71], a[128:131], a[4:7], v[68:71]
    v_mfma_f32_16x16x32_bf16 v[76:79], a[132:135], a[4:7], v[76:79]
    s_waitcnt lgkmcnt(0)
    s_barrier
    ds_read_b128 v[80:83], v8 offset:0
    ds_read_b128 v[84:87], v8 offset:1024
    ds_read_b128 v[88:91], v8 offset:2048
    ds_read_b128 v[92:95], v8 offset:3072
    ds_read_b128 v[96:99], v8 offset:4096
    ds_read_b128 v[100:103], v8 offset:5120
    ds_read_b128 v[104:107], v8 offset:6144
    ds_read_b128 v[108:111], v8 offset:7168
    ds_read_b128 v[112:115], v8 offset:8192
    ds_read_b128 v[116:119], v8 offset:9216
    s_add_u32 s46, s50, 4096
    s_waitcnt lgkmcnt(9)
    v_add_f32 v40, v40, v80
    v_add_f32 v41, v41, v81
    v_add_f32 v42, v42, v82
    v_add_f32 v43, v43, v83
    v_cvt_pk_bf16_f32 v40, v40, v41
    v_cvt_pk_bf16_f32 v41, v42, v43
    v_min_u32 v40, s49, v40
    v_min_u32 v41, s49, v41
    buffer_store_dwordx2 v[40:41], v11, s[28:31], s50 offen offset:0 sc1
    s_waitcnt lgkmcnt(7)
    v_add_f32 v48, v48, v88
    v_add_f32 v49, v49, v89
    v_add_f32 v50, v50, v90
    v_add_f32 v51, v51, v91
    v_cvt_pk_bf16_f32 v48, v48, v49
    v_cvt_pk_bf16_f32 v49, v50, v51
    v_min_u32 v48, s49, v48
    v_min_u32 v49, s49, v49
    buffer_store_dwordx2 v[48:49], v11, s[28:31], s50 offen offset:512 sc1
    s_waitcnt lgkmcnt(5)
    v_add_f32 v56, v56, v96
    v_add_f32 v57, v57, v97
    v_add_f32 v58, v58, v98
    v_add_f32 v59, v59, v99
    v_cvt_pk_bf16_f32 v56, v56, v57
    v_cvt_pk_bf16_f32 v57, v58, v59
    v_min_u32 v56, s49, v56
    v_min_u32 v57, s49, v57
    buffer_store_dwordx2 v[56:57], v11, s[28:31], s50 offen offset:1024 sc1
    s_waitcnt lgkmcnt(3)
    v_add_f32 v64, v64, v104
    v_add_f32 v65, v65, v105
    v_add_f32 v66, v66, v106
    v_add_f32 v67, v67, v107
    v_cvt_pk_bf16_f32 v64, v64, v65
    v_cvt_pk_bf16_f32 v65, v66, v67
    v_min_u32 v64, s49, v64
    v_min_u32 v65, s49, v65
    buffer_store_dwordx2 v[64:65], v11, s[28:31], s50 offen offset:1536 sc1
    s_waitcnt lgkmcnt(1)
    v_add_f32 v72, v72, v112
    v_add_f32 v73, v73, v113
    v_add_f32 v74, v74, v114
    v_add_f32 v75, v75, v115
    v_cvt_pk_bf16_f32 v72, v72, v73
    v_cvt_pk_bf16_f32 v73, v74, v75
    v_min_u32 v72, s49, v72
    v_min_u32 v73, s49, v73
    buffer_store_dwordx2 v[72:73], v11, s[28:31], s50 offen offset:2048 sc1
    s_waitcnt lgkmcnt(0)
    v_add_f32 v44, v44, v84
    v_add_f32 v45, v45, v85
    v_add_f32 v46, v46, v86
    v_add_f32 v47, v47, v87
    v_cvt_pk_bf16_f32 v44, v44, v45
    v_cvt_pk_bf16_f32 v45, v46, v47
    v_min_u32 v44, s49, v44
    v_min_u32 v45, s49, v45
    buffer_store_dwordx2 v[44:45], v11, s[28:31], s50 offen offset:2560 sc1
    s_waitcnt lgkmcnt(0)
    v_add_f32 v52, v52, v92
    v_add_f32 v53, v53, v93
    v_add_f32 v54, v54, v94
    v_add_f32 v55, v55, v95
    v_cvt_pk_bf16_f32 v52, v52, v53
    v_cvt_pk_bf16_f32 v53, v54, v55
    v_min_u32 v52, s49, v52
    v_min_u32 v53, s49, v53
    buffer_store_dwordx2 v[52:53], v11, s[28:31], s50 offen offset:3072 sc1
    s_waitcnt lgkmcnt(0)
    v_add_f32 v60, v60, v100
    v_add_f32 v61, v61, v101
    v_add_f32 v62, v62, v102
    v_add_f32 v63, v63, v103
    v_cvt_pk_bf16_f32 v60, v60, v61
    v_cvt_pk_bf16_f32 v61, v62, v63
    v_min_u32 v60, s49, v60
    v_min_u32 v61, s49, v61
    buffer_store_dwordx2 v[60:61], v11, s[28:31], s50 offen offset:3584 sc1
    s_waitcnt lgkmcnt(0)
    v_add_f32 v68, v68, v108
    v_add_f32 v69, v69, v109
    v_add_f32 v70, v70, v110
    v_add_f32 v71, v71, v111
    v_cvt_pk_bf16_f32 v68, v68, v69
    v_cvt_pk_bf16_f32 v69, v70, v71
    v_min_u32 v68, s49, v68
    v_min_u32 v69, s49, v69
    buffer_store_dwordx2 v[68:69], v11, s[28:31], s46 offen offset:0 sc1
    s_waitcnt lgkmcnt(0)
    v_add_f32 v76, v76, v116
    v_add_f32 v77, v77, v117
    v_add_f32 v78, v78, v118
    v_add_f32 v79, v79, v119
    v_cvt_pk_bf16_f32 v76, v76, v77
    v_cvt_pk_bf16_f32 v77, v78, v79
    v_min_u32 v76, s49, v76
    v_min_u32 v77, s49, v77
    buffer_store_dwordx2 v[76:77], v11, s[28:31], s46 offen offset:512 sc1
    v_mul_u32_u24 v22, 1280, v12
    v_lshl_add_u32 v22, v13, 3, v22
    s_lshl_b32 s62, s98, 9
    s_add_u32 s47, s51, s62
    s_mov_b32 s48, 0
L_1:
    s_add_u32 s62, s47, 0
    buffer_load_dwordx2 v[48:49], v11, s[28:31], s62 offen sc1
    s_add_u32 s62, s47, 20480
    buffer_load_dwordx2 v[50:51], v11, s[28:31], s62 offen sc1
    s_add_u32 s62, s47, 40960
    buffer_load_dwordx2 v[52:53], v11, s[28:31], s62 offen sc1
    s_add_u32 s62, s47, 61440
    buffer_load_dwordx2 v[54:55], v11, s[28:31], s62 offen sc1
    s_add_u32 s62, s47, 81920
    buffer_load_dwordx2 v[56:57], v11, s[28:31], s62 offen sc1
    s_add_u32 s62, s47, 102400
    buffer_load_dwordx2 v[58:59], v11, s[28:31], s62 offen sc1
    s_add_u32 s62, s47, 122880
    buffer_load_dwordx2 v[60:61], v11, s[28:31], s62 offen sc1
    s_add_u32 s62, s47, 143360
    buffer_load_dwordx2 v[62:63], v11, s[28:31], s62 offen sc1
    s_waitcnt vmcnt(0)
    v_max3_u32 v14, v48, v49, v50
    v_max3_u32 v14, v14, v51, v52
    v_max3_u32 v14, v14, v53, v54
    v_max3_u32 v14, v14, v55, v56
    v_max3_u32 v14, v14, v57, v58
    v_max3_u32 v14, v14, v59, v60
    v_max3_u32 v14, v14, v61, v62
    v_max_u32 v14, v14, v63
    v_cmp_eq_u32 vcc, -1, v14
    s_cbranch_vccz L_2
    s_add_u32 s48, s48, 1
    s_cmp_gt_u32 s48, 200000
    s_cbranch_scc0 L_1
L_2:
    v_lshlrev_b32 v16, 16, v48
    v_and_b32 v17, 0xffff0000, v48
    v_lshlrev_b32 v18, 16, v49
    v_and_b32 v19, 0xffff0000, v49
    v_lshlrev_b32 v20, 16, v50
    v_and_b32 v21, 0xffff0000, v50
    v_add_f32 v16, v16, v20
    v_add_f32 v17, v17, v21
    v_lshlrev_b32 v20, 16, v51
    v_and_b32 v21, 0xffff0000, v51
    v_add_f32 v18, v18, v20
    v_add_f32 v19, v19, v21
    v_lshlrev_b32 v20, 16, v52
    v_and_b32 v21, 0xffff0000, v52
    v_add_f32 v16, v16, v20
    v_add_f32 v17, v17, v21
    v_lshlrev_b32 v20, 16, v53
    v_and_b32 v21, 0xffff0000, v53
    v_add_f32 v18, v18, v20
    v_add_f32 v19, v19, v21
    v_lshlrev_b32 v20, 16, v54
    v_and_b32 v21, 0xffff0000, v54
    v_add_f32 v16, v16, v20
    v_add_f32 v17, v17, v21
    v_lshlrev_b32 v20, 16, v55
    v_and_b32 v21, 0xffff0000, v55
    v_add_f32 v18, v18, v20
    v_add_f32 v19, v19, v21
    v_lshlrev_b32 v20, 16, v56
    v_and_b32 v21, 0xffff0000, v56
    v_add_f32 v16, v16, v20
    v_add_f32 v17, v17, v21
    v_lshlrev_b32 v20, 16, v57
    v_and_b32 v21, 0xffff0000, v57
    v_add_f32 v18, v18, v20
    v_add_f32 v19, v19, v21
    v_lshlrev_b32 v20, 16, v58
    v_and_b32 v21, 0xffff0000, v58
    v_add_f32 v16, v16, v20
    v_add_f32 v17, v17, v21
    v_lshlrev_b32 v20, 16, v59
    v_and_b32 v21, 0xffff0000, v59
    v_add_f32 v18, v18, v20
    v_add_f32 v19, v19, v21
    v_lshlrev_b32 v20, 16, v60
    v_and_b32 v21, 0xffff0000, v60
    v_add_f32 v16, v16, v20
    v_add_f32 v17, v17, v21
    v_lshlrev_b32 v20, 16, v61
    v_and_b32 v21, 0xffff0000, v61
    v_add_f32 v18, v18, v20
    v_add_f32 v19, v19, v21
    v_lshlrev_b32 v20, 16, v62
    v_and_b32 v21, 0xffff0000, v62
    v_add_f32 v16, v16, v20
    v_add_f32 v17, v17, v21
    v_lshlrev_b32 v20, 16, v63
    v_and_b32 v21, 0xffff0000, v63
    v_add_f32 v18, v18, v20
    v_add_f32 v19, v19, v21
    v_cvt_pk_bf16_f32 v20, v16, v17
    v_cvt_pk_bf16_f32 v21, v18, v19
    s_lshl_b32 s62, s98, 5
    s_add_u32 s62, s62, s52
    buffer_store_dwordx2 v[20:21], v22, s[32:35], s62 offen
    s_endpgm
L_var1:
    v_lshlrev_b32 v3, 4, v9
    v_add_u32 v4, 0, v1
    v_mul_u32_u24 v5, 2731, v4
    v_lshrrev_b32 v5, 16, v5
    v_mul_u32_u24 v6, 24, v5
    v_sub_u32 v6, v4, v6
    v_bfe_u32 v7, v5, 1, 1
    v_lshlrev_b32 v7, 1, v7
    v_xor_b32 v6, v6, v7
    v_add_u32 v5, v5, v3
    v_mul_u32_u24 v5, 12288, v5
    v_lshl_add_u32 v24, v6, 4, v5
    v_add_u32 v27, 98304, v24
    v_xor_b32 v27, 64, v27
    v_add_u32 v4, 64, v1
    v_mul_u32_u24 v5, 2731, v4
    v_lshrrev_b32 v5, 16, v5
    v_mul_u32_u24 v6, 24, v5
    v_sub_u32 v6, v4, v6
    v_bfe_u32 v7, v5, 1, 1
    v_lshlrev_b32 v7, 1, v7
    v_xor_b32 v6, v6, v7
    v_add_u32 v5, v5, v3
    v_mul_u32_u24 v5, 12288, v5
    v_lshl_add_u32 v25, v6, 4, v5
    v_add_u32 v28, 98304, v25
    v_xor_b32 v28, 64, v28
    v_add_u32 v4, 128, v1
    v_mul_u32_u24 v5, 2731, v4
    v_lshrrev_b32 v5, 16, v5
    v_mul_u32_u24 v6, 24, v5
    v_sub_u32 v6, v4, v6
    v_bfe_u32 v7, v5, 1, 1
    v_lshlrev_b32 v7, 1, v7
    v_xor_b32 v6, v6, v7
    v_add_u32 v5, v5, v3
    v_mul_u32_u24 v5, 12288, v5
    v_lshl_add_u32 v26, v6, 4, v5
    v_add_u32 v29, 98304, v26
    v_xor_b32 v29, 64, v29
    v_lshrrev_b32 v5, 3, v1
    v_and_b32 v6, 7, v1
    v_lshrrev_b32 v7, 1, v5
    v_xor_b32 v6, v6, v7
    v_add_u32 v5, v5, v3
    v_mul_u32_u24 v7, 1280, v5
    v_lshl_add_u32 v30, v6, 4, v7
    v_add_u32 v31, 10240, v30
    v_xor_b32 v31, 64, v31
    v_mul_u32_u24 v7, 384, v5
    v_lshl_add_u32 v45, v6, 4, v7
    v_add_u32 v46, 3072, v45
    v_xor_b32 v46, 64, v46
    s_mul_i32 s59, s98, 6144
    s_mul_i32 s60, s98, 5120
    s_mov_b32 s56, s4
    s_mul_i32 s62, s4, 81920
    s_mul_i32 s63, s7, 384
    s_waitcnt lgkmcnt(0)
    s_add_u32 s8, s40, s62
    s_addc_u32 s9, s41, 0
    s_mov_b32 s10, 81920
    s_mov_b32 s11, 0x00020000
    s_add_u32 s12, s46, s63
    s_addc_u32 s13, s47, 0
    s_mov_b32 s14, 7852416
    s_mov_b32 s15, 0x00020000
    s_mul_i32 s57, s56, 786432
    s_lshl_b32 s58, s56, 7
    s_add_u32 m0, s59, 0
    s_nop 0
    buffer_load_dwordx4 v24, s[12:15], s57 offen lds
    s_add_u32 m0, s59, 1024
    s_nop 0
    buffer_load_dwordx4 v25, s[12:15], s57 offen lds
    s_add_u32 m0, s59, 2048
    s_nop 0
    buffer_load_dwordx4 v26, s[12:15], s57 offen lds
    s_add_u32 m0, s59, 3072
    s_nop 0
    buffer_load_dwordx4 v27, s[12:15], s57 offen lds
    s_add_u32 m0, s59, 4096
    s_nop 0
    buffer_load_dwordx4 v28, s[12:15], s57 offen lds
    s_add_u32 m0, s59, 5120
    s_nop 0
    buffer_load_dwordx4 v29, s[12:15], s57 offen lds
    s_add_u32 m0, s100, 24576
    s_nop 0
    buffer_load_dwordx4 v30, s[8:11], s58 offen lds
    s_add_u32 m0, s100, 25600
    s_nop 0
    buffer_load_dwordx4 v31, s[8:11], s58 offen lds
    s_add_u32 s56, s56, 1
    s_cmp_ge_u32 s56, 10
    s_cselect_b32 s56, 0, s56
    v_and_b32 v12, 15, v1
    v_lshrrev_b32 v13, 4, v1
    v_lshlrev_b32 v10, 4, v1
    v_lshlrev_b32 v11, 3, v1
    s_mul_i32 s62, s6, 160
    s_mul_i32 s63, s98, 40
    s_add_u32 s62, s62, s63
    v_min_u32 v4, 39, v1
    v_add_u32 v4, s62, v4
    v_lshlrev_b32 v19, 7, v4
    s_mul_i32 s62, s4, 48
    s_mul_i32 s63, s98, 12
    s_add_u32 s62, s62, s63
    v_min_u32 v4, 11, v1
    v_add_u32 v4, s62, v4
    v_mul_u32_u24 v5, 21846, v4
    v_lshrrev_b32 v5, 16, v5
    v_mul_u32_u24 v6, 3, v5
    v_sub_u32 v6, v4, v6
    v_add_u32 v5, 512, v5
    v_mul_u32_u24 v5, 12288, v5
    v_lshl_add_u32 v20, v6, 7, v5
    buffer_load_dword v80, v19, s[8:11], 0 offen
    buffer_load_dword v81, v20, s[12:15], 0 offen
    s_lshl_b32 s62, s4, 5
    s_add_u32 s63, s62, s7
    s_mul_i32 s63, s63, 24576
    s_add_u32 s16, s42, s63
    s_addc_u32 s17, s43, 0
    s_mov_b32 s18, 24576
    s_mov_b32 s19, 0x00020000
    s_lshl_b32 s63, s5, 2
    s_add_u32 s63, s63, s62
    s_mul_i32 s63, s63, 24576
    s_add_u32 s20, s44, s63
    s_addc_u32 s21, s45, 0
    s_mov_b32 s22, 98304
    s_mov_b32 s23, 0x00020000
    s_mul_i32 s62, s5, 983040
    s_mul_i32 s63, s6, 320
    s_add_u32 s62, s62, s63
    s_add_u32 s24, s48, s62
    s_addc_u32 s25, s49, 0
    s_mov_b32 s26, 982080
    s_mov_b32 s27, 0x00020000
    s_mov_b32 s32, s50
    s_mov_b32 s33, s51
    s_mov_b32 s34, 655360
    s_mov_b32 s35, 0x00020000
    s_mov_b32 s36, s52
    s_mov_b32 s37, s53
    s_mov_b32 s38, 256
    s_mov_b32 s39, 0x00020000
    s_mov_b32 s28, s54
    s_mov_b32 s29, s55
    s_mov_b32 s30, 268435456
    s_mov_b32 s31, 0x00020000
    s_lshl_b32 s62, s4, 5
    s_add_u32 s62, s62, s7
    s_lshl_b32 s45, s62, 13
    s_lshl_b32 s63, s62, 7
    s_add_u32 s53, s63, 8388608
    s_lshl_b32 s62, s4, 5
    s_lshl_b32 s63, s5, 2
    s_add_u32 s63, s63, s62
    s_lshl_b32 s63, s63, 7
    s_add_u32 s43, s63, 8388608
    s_lshl_b32 s62, s4, 2
    s_add_u32 s62, s62, s6
    s_lshl_b32 s63, s62, 3
    s_add_u32 s63, s63, s5
    s_mul_i32 s63, s63, 20480
    s_add_u32 s63, s63, 2097152
    s_mul_i32 s50, s98, 5120
    s_add_u32 s50, s50, s63
    s_mul_i32 s62, s62, 163840
    s_mul_i32 s63, s5, 2560
    s_add_u32 s62, s62, s63
    s_add_u32 s51, s62, 2097152
    s_lshr_b32 s62, s5, 2
    s_lshl_b32 s62, s62, 1
    s_and_b32 s63, s5, 1
    s_add_u32 s62, s62, s63
    s_lshl_b32 s62, s62, 4
    s_lshl_b32 s63, s4, 6
    s_add_u32 s62, s62, s63
    s_mul_i32 s62, s62, 1280
    s_mul_i32 s63, s6, 320
    s_add_u32 s62, s62, s63
    s_lshr_b32 s63, s5, 1
    s_and_b32 s63, s63, 1
    s_mul_i32 s63, s63, 160
    s_add_u32 s52, s62, s63
    s_mov_b32 s49, 0xfffffffe
    s_lshl_b32 s62, s4, 5
    s_add_u32 s62, s62, s6
    s_lshl_b32 s62, s62, 7
    s_add_u32 s42, s62, 8388608
    s_lshr_b32 s62, s4, 1
    s_add_u32 s62, s62, s6
    s_and_b32 s61, s62, 3
    s_and_b32 s62, s4, 1
    s_lshl_b32 s41, s62, 1
    v_add_u32 v4, 0, v1
    v_mul_u32_u24 v5, 2731, v4
    v_lshrrev_b32 v5, 16, v5
    v_mul_u32_u24 v6, 24, v5
    v_sub_u32 v6, v4, v6
    v_bfe_u32 v7, v5, 1, 3
    v_xor_b32 v6, v6, v7
    v_add_u32 v5, v5, v3
    v_mul_u32_u24 v5, 384, v5
    v_lshl_add_u32 v32, v6, 4, v5
    v_add_u32 v4, 64, v1
    v_mul_u32_u24 v5, 2731, v4
    v_lshrrev_b32 v5, 16, v5
    v_mul_u32_u24 v6, 24, v5
    v_sub_u32 v6, v4, v6
    v_bfe_u32 v7, v5, 1, 3
    v_xor_b32 v6, v6, v7
    v_add_u32 v5, v5, v3
    v_mul_u32_u24 v5, 384, v5
    v_lshl_add_u32 v33, v6, 4, v5
    v_add_u32 v4, 128, v1
    v_mul_u32_u24 v5, 2731, v4
    v_lshrrev_b32 v5, 16, v5
    v_mul_u32_u24 v6, 24, v5
    v_sub_u32 v6, v4, v6
    v_bfe_u32 v7, v5, 1, 3
    v_xor_b32 v6, v6, v7
    v_add_u32 v5, v5, v3
    v_mul_u32_u24 v5, 384, v5
    v_lshl_add_u32 v34, v6, 4, v5
    v_add_u32 v4, 192, v1
    v_mul_u32_u24 v5, 2731, v4
    v_lshrrev_b32 v5, 16, v5
    v_mul_u32_u24 v6, 24, v5
    v_sub_u32 v6, v4, v6
    v_bfe_u32 v7, v5, 1, 3
    v_xor_b32 v6, v6, v7
    v_add_u32 v5, v5, v3
    v_mul_u32_u24 v5, 384, v5
    v_lshl_add_u32 v35, v6, 4, v5
    v_add_u32 v4, 256, v1
    v_mul_u32_u24 v5, 2731, v4
    v_lshrrev_b32 v5, 16, v5
    v_mul_u32_u24 v6, 24, v5
    v_sub_u32 v6, v4, v6
    v_bfe_u32 v7, v5, 1, 3
    v_xor_b32 v6, v6, v7
    v_add_u32 v5, v5, v3
    v_mul_u32_u24 v5, 384, v5
    v_lshl_add_u32 v36, v6, 4, v5
    v_add_u32 v4, 320, v1
    v_mul_u32_u24 v5, 2731, v4
    v_lshrrev_b32 v5, 16, v5
    v_mul_u32_u24 v6, 24, v5
    v_sub_u32 v6, v4, v6
    v_bfe_u32 v7, v5, 1, 3
    v_xor_b32 v6, v6, v7
    v_add_u32 v5, v5, v3
    v_mul_u32_u24 v5, 384, v5
    v_lshl_add_u32 v37, v6, 4, v5
    v_add_u32 v4, 0, v1
    v_mul_u32_u24 v5, 3277, v4
    v_lshrrev_b32 v5, 16, v5
    v_mul_u32_u24 v6, 20, v5
    v_sub_u32 v6, v4, v6
    v_bfe_u32 v7, v5, 3, 1
    v_lshlrev_b32 v7, 1, v7
    v_xor_b32 v6, v6, v7
    v_add_u32 v5, v5, v3
    v_mul_u32_u24 v5, 1280, v5
    v_lshl_add_u32 v40, v6, 4, v5
    v_add_u32 v4, 64, v1
    v_mul_u32_u24 v5, 3277, v4
    v_lshrrev_b32 v5, 16, v5
    v_mul_u32_u24 v6, 20, v5
    v_sub_u32 v6, v4, v6
    v_bfe_u32 v7, v5, 3, 1
    v_lshlrev_b32 v7, 1, v7
    v_xor_b32 v6, v6, v7
    v_add_u32 v5, v5, v3
    v_mul_u32_u24 v5, 1280, v5
    v_lshl_add_u32 v41, v6, 4, v5
    v_add_u32 v4, 128, v1
    v_mul_u32_u24 v5, 3277, v4
    v_lshrrev_b32 v5, 16, v5
    v_mul_u32_u24 v6, 20, v5
    v_sub_u32 v6, v4, v6
    v_bfe_u32 v7, v5, 3, 1
    v_lshlrev_b32 v7, 1, v7
    v_xor_b32 v6, v6, v7
    v_add_u32 v5, v5, v3
    v_mul_u32_u24 v5, 1280, v5
    v_lshl_add_u32 v42, v6, 4, v5
    v_add_u32 v4, 192, v1
    v_mul_u32_u24 v5, 3277, v4
    v_lshrrev_b32 v5, 16, v5
    v_mul_u32_u24 v6, 20, v5
    v_sub_u32 v6, v4, v6
    v_bfe_u32 v7, v5, 3, 1
    v_lshlrev_b32 v7, 1, v7
    v_xor_b32 v6, v6, v7
    v_add_u32 v5, v5, v3
    v_mul_u32_u24 v5, 1280, v5
    v_lshl_add_u32 v43, v6, 4, v5
    v_add_u32 v4, 256, v1
    v_mul_u32_u24 v5, 3277, v4
    v_lshrrev_b32 v5, 16, v5
    v_mul_u32_u24 v6, 20, v5
    v_sub_u32 v6, v4, v6
    v_bfe_u32 v7, v5, 3, 1
    v_lshlrev_b32 v7, 1, v7
    v_xor_b32 v6, v6, v7
    v_add_u32 v5, v5, v3
    v_mul_u32_u24 v5, 1280, v5
    v_lshl_add_u32 v44, v6, 4, v5
    v_mov_b32 v16, 0
    v_mov_b32 v22, 0
    v_mov_b32 v84, -1
    v_mov_b32 v85, -1
    v_mov_b32 v86, -1
    v_mov_b32 v87, -1
    s_mul_i32 s57, s56, 786432
    s_lshl_b32 s58, s56, 7
    s_add_u32 m0, s59, 32768
    s_nop 0
    buffer_load_dwordx4 v24, s[12:15], s57 offen lds
    s_add_u32 m0, s59, 33792
    s_nop 0
    buffer_load_dwordx4 v25, s[12:15], s57 offen lds
    s_add_u32 m0, s59, 34816
    s_nop 0
    buffer_load_dwordx4 v26, s[12:15], s57 offen lds
    s_add_u32 m0, s59, 35840
    s_nop 0
    buffer_load_dwordx4 v27, s[12:15], s57 offen lds
    s_add_u32 m0, s59, 36864
    s_nop 0
    buffer_load_dwordx4 v28, s[12:15], s57 offen lds
    s_add_u32 m0, s59, 37888
    s_nop 0
    buffer_load_dwordx4 v29, s[12:15], s57 offen lds
    s_add_u32 m0, s100, 57344
    s_nop 0
    buffer_load_dwordx4 v30, s[8:11], s58 offen lds
    s_add_u32 m0, s100, 58368
    s_nop 0
    buffer_load_dwordx4 v31, s[8:11], s58 offen lds
    s_add_u32 s56, s56, 1
    s_cmp_ge_u32 s56, 10
    s_cselect_b32 s56, 0, s56
    s_waitcnt vmcnt(10)
    s_barrier
    s_mul_i32 s57, s56, 786432
    s_lshl_b32 s58, s56, 7
    s_add_u32 m0, s59, 65536
    s_nop 0
    buffer_load_dwordx4 v24, s[12:15], s57 offen lds
    s_add_u32 m0, s59, 66560
    s_nop 0
    buffer_load_dwordx4 v25, s[12:15], s57 offen lds
    s_add_u32 m0, s59, 67584
    s_nop 0
    buffer_load_dwordx4 v26, s[12:15], s57 offen lds
    s_add_u32 m0, s59, 68608
    s_nop 0
    buffer_load_dwordx4 v27, s[12:15], s57 offen lds
    s_add_u32 m0, s59, 69632
    s_nop 0
    buffer_load_dwordx4 v28, s[12:15], s57 offen lds
    s_add_u32 m0, s59, 70656
    s_nop 0
    buffer_load_dwordx4 v29, s[12:15], s57 offen lds
    s_add_u32 m0, s100, 90112
    s_nop 0
    buffer_load_dwordx4 v30, s[8:11], s58 offen lds
    s_add_u32 m0, s100, 91136
    s_nop 0
    buffer_load_dwordx4 v31, s[8:11], s58 offen lds
    s_add_u32 s56, s56, 1
    s_cmp_ge_u32 s56, 10
    s_cselect_b32 s56, 0, s56
    s_waitcnt vmcnt(8)
    s_barrier
    s_mul_i32 s57, s56, 786432
    s_lshl_b32 s58, s56, 7
    s_add_u32 m0, s59, 0
    s_nop 0
    buffer_load_dwordx4 v24, s[12:15], s57 offen lds
    s_add_u32 m0, s59, 1024
    s_nop 0
    buffer_load_dwordx4 v25, s[12:15], s57 offen lds
    s_add_u32 m0, s59, 2048
    s_nop 0
    buffer_load_dwordx4 v26, s[12:15], s57 offen lds
    s_add_u32 m0, s59, 3072
    s_nop 0
    buffer_load_dwordx4 v27, s[12:15], s57 offen lds
    s_add_u32 m0, s59, 4096
    s_nop 0
    buffer_load_dwordx4 v28, s[12:15], s57 offen lds
    s_add_u32 m0, s59, 5120
    s_nop 0
    buffer_load_dwordx4 v29, s[12:15], s57 offen lds
    s_add_u32 m0, s100, 24576
    s_nop 0
    buffer_load_dwordx4 v30, s[8:11], s58 offen lds
    s_add_u32 m0, s100, 25600
    s_nop 0
    buffer_load_dwordx4 v31, s[8:11], s58 offen lds
    s_add_u32 s56, s56, 1
    s_cmp_ge_u32 s56, 10
    s_cselect_b32 s56, 0, s56
    s_cmp_lg_u32 s98, 0
    s_cbranch_scc1 L_14
    v_lshlrev_b32 v4, 2, v1
    v_mov_b32 v5, 0
    s_mov_b64 s[62:63], exec
    s_mov_b64 exec, 0xff
    buffer_store_dword v5, v4, s[28:31], s53 offen sc1
    s_mov_b64 exec, s[62:63]
L_14:
    s_add_u32 s63, s50, 0
    buffer_store_dwordx4 v[84:87], v10, s[28:31], s63 offen sc1
    s_waitcnt vmcnt(8)
    s_barrier
    s_mul_i32 s57, s56, 786432
    s_lshl_b32 s58, s56, 7
    s_add_u32 m0, s59, 32768
    s_nop 0
    buffer_load_dwordx4 v24, s[12:15], s57 offen lds
    s_add_u32 m0, s59, 33792
    s_nop 0
    buffer_load_dwordx4 v25, s[12:15], s57 offen lds
    s_add_u32 m0, s59, 34816
    s_nop 0
    buffer_load_dwordx4 v26, s[12:15], s57 offen lds
    s_add_u32 m0, s59, 35840
    s_nop 0
    buffer_load_dwordx4 v27, s[12:15], s57 offen lds
    s_add_u32 m0, s59, 36864
    s_nop 0
    buffer_load_dwordx4 v28, s[12:15], s57 offen lds
    s_add_u32 m0, s59, 37888
    s_nop 0
    buffer_load_dwordx4 v29, s[12:15], s57 offen lds
    s_add_u32 m0, s100, 57344
    s_nop 0
    buffer_load_dwordx4 v30, s[8:11], s58 offen lds
    s_add_u32 m0, s100, 58368
    s_nop 0
    buffer_load_dwordx4 v31, s[8:11], s58 offen lds
    s_add_u32 s56, s56, 1
    s_cmp_ge_u32 s56, 10
    s_cselect_b32 s56, 0, s56
    s_add_u32 m0, s59, 131072
    s_nop 0
    buffer_load_dwordx4 v32, s[16:19], 0 offen nt lds
    s_add_u32 m0, s59, 132096
    s_nop 0
    buffer_load_dwordx4 v33, s[16:19], 0 offen nt lds
    s_add_u32 m0, s59, 133120
    s_nop 0
    buffer_load_dwordx4 v34, s[16:19], 0 offen nt lds
    s_add_u32 m0, s59, 134144
    s_nop 0
    buffer_load_dwordx4 v35, s[16:19], 0 offen nt lds
    s_add_u32 m0, s59, 135168
    s_nop 0
    buffer_load_dwordx4 v36, s[16:19], 0 offen nt lds
    s_add_u32 m0, s59, 136192
    s_nop 0
    buffer_load_dwordx4 v37, s[16:19], 0 offen nt lds
    s_add_u32 s63, s50, 1024
    buffer_store_dwordx4 v[84:87], v10, s[28:31], s63 offen sc1
    s_waitcnt vmcnt(14)
    s_barrier
    s_mul_i32 s57, s56, 786432
    s_lshl_b32 s58, s56, 7
    s_add_u32 m0, s59, 65536
    s_nop 0
    buffer_load_dwordx4 v24, s[12:15], s57 offen lds
    s_add_u32 m0, s59, 66560
    s_nop 0
    buffer_load_dwordx4 v25, s[12:15], s57 offen lds
    s_add_u32 m0, s59, 67584
    s_nop 0
    buffer_load_dwordx4 v26, s[12:15], s57 offen lds
    s_add_u32 m0, s59, 68608
    s_nop 0
    buffer_load_dwordx4 v27, s[12:15], s57 offen lds
    s_add_u32 m0, s59, 69632
    s_nop 0
    buffer_load_dwordx4 v28, s[12:15], s57 offen lds
    s_add_u32 m0, s59, 70656
    s_nop 0
    buffer_load_dwordx4 v29, s[12:15], s57 offen lds
    s_add_u32 m0, s100, 90112
    s_nop 0
    buffer_load_dwordx4 v30, s[8:11], s58 offen lds
    s_add_u32 m0, s100, 91136
    s_nop 0
    buffer_load_dwordx4 v31, s[8:11], s58 offen lds
    s_add_u32 s56, s56, 1
    s_cmp_ge_u32 s56, 10
    s_cselect_b32 s56, 0, s56
    s_add_u32 s63, s50, 2048
    buffer_store_dwordx4 v[84:87], v10, s[28:31], s63 offen sc1
    s_waitcnt vmcnt(14)
    s_barrier
    s_mul_i32 s57, s56, 786432
    s_lshl_b32 s58, s56, 7
    s_add_u32 m0, s59, 0
    s_nop 0
    buffer_load_dwordx4 v24, s[12:15], s57 offen lds
    s_add_u32 m0, s59, 1024
    s_nop 0
    buffer_load_dwordx4 v25, s[12:15], s57 offen lds
    s_add_u32 m0, s59, 2048
    s_nop 0
    buffer_load_dwordx4 v26, s[12:15], s57 offen lds
    s_add_u32 m0, s59, 3072
    s_nop 0
    buffer_load_dwordx4 v27, s[12:15], s57 offen lds
    s_add_u32 m0, s59, 4096
    s_nop 0
    buffer_load_dwordx4 v28, s[12:15], s57 offen lds
    s_add_u32 m0, s59, 5120
    s_nop 0
    buffer_load_dwordx4 v29, s[12:15], s57 offen lds
    s_add_u32 m0, s100, 24576
    s_nop 0
    buffer_load_dwordx4 v30, s[8:11], s58 offen lds
    s_add_u32 m0, s100, 25600
    s_nop 0
    buffer_load_dwordx4 v31, s[8:11], s58 offen lds
    s_add_u32 s56, s56, 1
    s_cmp_ge_u32 s56, 10
    s_cselect_b32 s56, 0, s56
    s_add_u32 s63, s50, 3072
    buffer_store_dwordx4 v[84:87], v10, s[28:31], s63 offen sc1
    s_waitcnt vmcnt(8)
    s_barrier
    s_mul_i32 s57, s56, 786432
    s_lshl_b32 s58, s56, 7
    s_add_u32 m0, s59, 32768
    s_nop 0
    buffer_load_dwordx4 v24, s[12:15], s57 offen lds
    s_add_u32 m0, s59, 33792
    s_nop 0
    buffer_load_dwordx4 v25, s[12:15], s57 offen lds
    s_add_u32 m0, s59, 34816
    s_nop 0
    buffer_load_dwordx4 v26, s[12:15], s57 offen lds
    s_add_u32 m0, s59, 35840
    s_nop 0
    buffer_load_dwordx4 v27, s[12:15], s57 offen lds
    s_add_u32 m0, s59, 36864
    s_nop 0
    buffer_load_dwordx4 v28, s[12:15], s57 offen lds
    s_add_u32 m0, s59, 37888
    s_nop 0
    buffer_load_dwordx4 v29, s[12:15], s57 offen lds
    s_add_u32 m0, s100, 57344
    s_nop 0
    buffer_load_dwordx4 v30, s[8:11], s58 offen lds
    s_add_u32 m0, s100, 58368
    s_nop 0
    buffer_load_dwordx4 v31, s[8:11], s58 offen lds
    s_add_u32 s56, s56, 1
    s_cmp_ge_u32 s56, 10
    s_cselect_b32 s56, 0, s56
    s_add_u32 s63, s50, 4096
    buffer_store_dwordx4 v[84:87], v10, s[28:31], s63 offen sc1
    s_waitcnt vmcnt(8)
    s_waitcnt vmcnt(24)
    s_barrier
    s_mul_i32 s57, s56, 786432
    s_lshl_b32 s58, s56, 7
    s_add_u32 m0, s59, 65536
    s_nop 0
    buffer_load_dwordx4 v24, s[12:15], s57 offen lds
    s_add_u32 m0, s59, 66560
    s_nop 0
    buffer_load_dwordx4 v25, s[12:15], s57 offen lds
    s_add_u32 m0, s59, 67584
    s_nop 0
    buffer_load_dwordx4 v26, s[12:15], s57 offen lds
    s_add_u32 m0, s59, 68608
    s_nop 0
    buffer_load_dwordx4 v27, s[12:15], s57 offen lds
    s_add_u32 m0, s59, 69632
    s_nop 0
    buffer_load_dwordx4 v28, s[12:15], s57 offen lds
    s_add_u32 m0, s59, 70656
    s_nop 0
    buffer_load_dwordx4 v29, s[12:15], s57 offen lds
    s_add_u32 m0, s100, 90112
    s_nop 0
    buffer_load_dwordx4 v30, s[8:11], s58 offen lds
    s_add_u32 m0, s100, 91136
    s_nop 0
    buffer_load_dwordx4 v31, s[8:11], s58 offen lds
    s_add_u32 s56, s56, 1
    s_cmp_ge_u32 s56, 10
    s_cselect_b32 s56, 0, s56
    s_add_u32 s62, s61, 0
    s_and_b32 s62, s62, 3
    s_add_u32 s63, s41, 0
    s_cmp_ge_u32 s63, 3
    s_cselect_b32 s46, 3, 0
    s_sub_u32 s63, s63, s46
    s_mul_i32 s40, s62, 245760
    s_mul_i32 s46, s63, 81920
    s_add_u32 s40, s40, s46
    s_mul_i32 s101, s62, 24576
    s_lshl_b32 s46, s63, 7
    s_add_u32 s101, s101, s46
    s_add_u32 m0, s60, 98304
    s_nop 0
    buffer_load_dwordx4 v40, s[24:27], s40 offen lds
    s_add_u32 m0, s60, 99328
    s_nop 0
    buffer_load_dwordx4 v41, s[24:27], s40 offen lds
    s_add_u32 m0, s60, 100352
    s_nop 0
    buffer_load_dwordx4 v42, s[24:27], s40 offen lds
    s_add_u32 m0, s60, 101376
    s_nop 0
    buffer_load_dwordx4 v43, s[24:27], s40 offen lds
    s_add_u32 m0, s60, 102400
    s_nop 0
    buffer_load_dwordx4 v44, s[24:27], s40 offen lds
    s_add_u32 m0, s100, 118784
    s_nop 0
    buffer_load_dwordx4 v45, s[20:23], s101 offen lds
    s_add_u32 m0, s100, 119808
    s_nop 0
    buffer_load_dwordx4 v46, s[20:23], s101 offen lds
    s_waitcnt vmcnt(15)
    s_barrier
    s_mul_i32 s57, s56, 786432
    s_lshl_b32 s58, s56, 7
    s_add_u32 m0, s59, 0
    s_nop 0
    buffer_load_dwordx4 v24, s[12:15], s57 offen lds
    s_add_u32 m0, s59, 1024
    s_nop 0
    buffer_load_dwordx4 v25, s[12:15], s57 offen lds
    s_add_u32 m0, s59, 2048
    s_nop 0
    buffer_load_dwordx4 v26, s[12:15], s57 offen lds
    s_add_u32 m0, s59, 3072
    s_nop 0
    buffer_load_dwordx4 v27, s[12:15], s57 offen lds
    s_add_u32 m0, s59, 4096
    s_nop 0
    buffer_load_dwordx4 v28, s[12:15], s57 offen lds
    s_add_u32 m0, s59, 5120
    s_nop 0
    buffer_load_dwordx4 v29, s[12:15], s57 offen lds
    s_add_u32 m0, s100, 24576
    s_nop 0
    buffer_load_dwordx4 v30, s[8:11], s58 offen lds
    s_add_u32 m0, s100, 25600
    s_nop 0
    buffer_load_dwordx4 v31, s[8:11], s58 offen lds
    s_add_u32 s56, s56, 1
    s_cmp_ge_u32 s56, 10
    s_cselect_b32 s56, 0, s56
    s_waitcnt vmcnt(15)
    s_barrier
    s_add_u32 s62, s61, 0
    s_and_b32 s62, s62, 3
    s_add_u32 s63, s41, 1
    s_cmp_ge_u32 s63, 3
    s_cselect_b32 s46, 3, 0
    s_sub_u32 s63, s63, s46
    s_mul_i32 s40, s62, 245760
    s_mul_i32 s46, s63, 81920
    s_add_u32 s40, s40, s46
    s_mul_i32 s101, s62, 24576
    s_lshl_b32 s46, s63, 7
    s_add_u32 s101, s101, s46
    s_add_u32 m0, s60, 32768
    s_nop 0
    buffer_load_dwordx4 v40, s[24:27], s40 offen lds
    s_add_u32 m0, s60, 33792
    s_nop 0
    buffer_load_dwordx4 v41, s[24:27], s40 offen lds
    s_add_u32 m0, s60, 34816
    s_nop 0
    buffer_load_dwordx4 v42, s[24:27], s40 offen lds
    s_add_u32 m0, s60, 35840
    s_nop 0
    buffer_load_dwordx4 v43, s[24:27], s40 offen lds
    s_add_u32 m0, s60, 36864
    s_nop 0
    buffer_load_dwordx4 v44, s[24:27], s40 offen lds
    s_add_u32 m0, s100, 53248
    s_nop 0
    buffer_load_dwordx4 v45, s[20:23], s101 offen lds
    s_add_u32 m0, s100, 54272
    s_nop 0
    buffer_load_dwordx4 v46, s[20:23], s101 offen lds
    s_add_u32 s62, s61, 0
    s_and_b32 s62, s62, 3
    s_add_u32 s63, s41, 2
    s_cmp_ge_u32 s63, 3
    s_cselect_b32 s46, 3, 0
    s_sub_u32 s63, s63, s46
    s_mul_i32 s40, s62, 245760
    s_mul_i32 s46, s63, 81920
    s_add_u32 s40, s40, s46
    s_mul_i32 s101, s62, 24576
    s_lshl_b32 s46, s63, 7
    s_add_u32 s101, s101, s46
    v_and_b32 v4, 15, v1
    v_add_u32 v4, v4, v3
    v_mul_u32_u24 v4, 384, v4
    buffer_load_dword v82, v4, s[20:23], s101 offen
    s_waitcnt vmcnt(8)
    s_barrier
    s_add_u32 s62, s61, 0
    s_and_b32 s62, s62, 3
    s_add_u32 s63, s41, 2
    s_cmp_ge_u32 s63, 3
    s_cselect_b32 s46, 3, 0
    s_sub_u32 s63, s63, s46
    s_mul_i32 s40, s62, 245760
    s_mul_i32 s46, s63, 81920
    s_add_u32 s40, s40, s46
    s_mul_i32 s101, s62, 24576
    s_lshl_b32 s46, s63, 7
    s_add_u32 s101, s101, s46
    s_add_u32 m0, s60, 65536
    s_nop 0
    buffer_load_dwordx4 v40, s[24:27], s40 offen lds
    s_add_u32 m0, s60, 66560
    s_nop 0
    buffer_load_dwordx4 v41, s[24:27], s40 offen lds
    s_add_u32 m0, s60, 67584
    s_nop 0
    buffer_load_dwordx4 v42, s[24:27], s40 offen lds
    s_add_u32 m0, s60, 68608
    s_nop 0
    buffer_load_dwordx4 v43, s[24:27], s40 offen lds
    s_add_u32 m0, s60, 69632
    s_nop 0
    buffer_load_dwordx4 v44, s[24:27], s40 offen lds
    s_add_u32 m0, s100, 86016
    s_nop 0
    buffer_load_dwordx4 v45, s[20:23], s101 offen lds
    s_add_u32 m0, s100, 87040
    s_nop 0
    buffer_load_dwordx4 v46, s[20:23], s101 offen lds
    s_waitcnt vmcnt(23)
    s_waitcnt vmcnt(38)
    s_barrier
    s_cmp_lg_u32 s98, 0
    s_cbranch_scc1 L_15
    s_lshl_b32 s62, s4, 5
    v_mov_b32 v4, s62
    v_mov_b32 v5, 1
    s_mov_b64 s[62:63], exec
    s_mov_b64 exec, 1
    buffer_atomic_add v5, v4, s[36:39], 0 offen offset:0 sc1
    s_mov_b64 exec, s[62:63]
L_15:
    s_waitcnt vmcnt(8)
    s_barrier
    s_add_u32 s62, s61, 1
    s_and_b32 s62, s62, 3
    s_add_u32 s63, s41, 0
    s_cmp_ge_u32 s63, 3
    s_cselect_b32 s46, 3, 0
    s_sub_u32 s63, s63, s46
    s_mul_i32 s40, s62, 245760
    s_mul_i32 s46, s63, 81920
    s_add_u32 s40, s40, s46
    s_mul_i32 s101, s62, 24576
    s_lshl_b32 s46, s63, 7
    s_add_u32 s101, s101, s46
    s_add_u32 m0, s60, 98304
    s_nop 0
    buffer_load_dwordx4 v40, s[24:27], s40 offen lds
    s_add_u32 m0, s60, 99328
    s_nop 0
    buffer_load_dwordx4 v41, s[24:27], s40 offen lds
    s_add_u32 m0, s60, 100352
    s_nop 0
    buffer_load_dwordx4 v42, s[24:27], s40 offen lds
    s_add_u32 m0, s60, 101376
    s_nop 0
    buffer_load_dwordx4 v43, s[24:27], s40 offen lds
    s_add_u32 m0, s60, 102400
    s_nop 0
    buffer_load_dwordx4 v44, s[24:27], s40 offen lds
    s_add_u32 m0, s100, 118784
    s_nop 0
    buffer_load_dwordx4 v45, s[20:23], s101 offen lds
    s_add_u32 m0, s100, 119808
    s_nop 0
    buffer_load_dwordx4 v46, s[20:23], s101 offen lds
    s_waitcnt vmcnt(7)
    s_barrier
    s_add_u32 s62, s61, 1
    s_and_b32 s62, s62, 3
    s_add_u32 s63, s41, 1
    s_cmp_ge_u32 s63, 3
    s_cselect_b32 s46, 3, 0
    s_sub_u32 s63, s63, s46
    s_mul_i32 s40, s62, 245760
    s_mul_i32 s46, s63, 81920
    s_add_u32 s40, s40, s46
    s_mul_i32 s101, s62, 24576
    s_lshl_b32 s46, s63, 7
    s_add_u32 s101, s101, s46
    s_add_u32 m0, s60, 0
    s_nop 0
    buffer_load_dwordx4 v40, s[24:27], s40 offen lds
    s_add_u32 m0, s60, 1024
    s_nop 0
    buffer_load_dwordx4 v41, s[24:27], s40 offen lds
    s_add_u32 m0, s60, 2048
    s_nop 0
    buffer_load_dwordx4 v42, s[24:27], s40 offen lds
    s_add_u32 m0, s60, 3072
    s_nop 0
    buffer_load_dwordx4 v43, s[24:27], s40 offen lds
    s_add_u32 m0, s60, 4096
    s_nop 0
    buffer_load_dwordx4 v44, s[24:27], s40 offen lds
    s_add_u32 m0, s100, 20480
    s_nop 0
    buffer_load_dwordx4 v45, s[20:23], s101 offen lds
    s_add_u32 m0, s100, 21504
    s_nop 0
    buffer_load_dwordx4 v46, s[20:23], s101 offen lds
    s_add_u32 s62, s61, 1
    s_and_b32 s62, s62, 3
    s_add_u32 s63, s41, 2
    s_cmp_ge_u32 s63, 3
    s_cselect_b32 s46, 3, 0
    s_sub_u32 s63, s63, s46
    s_mul_i32 s40, s62, 245760
    s_mul_i32 s46, s63, 81920
    s_add_u32 s40, s40, s46
    s_mul_i32 s101, s62, 24576
    s_lshl_b32 s46, s63, 7
    s_add_u32 s101, s101, s46
    s_add_u32 m0, s60, 131072
    s_nop 0
    buffer_load_dwordx4 v40, s[24:27], s40 offen lds
    s_add_u32 m0, s60, 132096
    s_nop 0
    buffer_load_dwordx4 v41, s[24:27], s40 offen lds
    s_add_u32 m0, s60, 133120
    s_nop 0
    buffer_load_dwordx4 v42, s[24:27], s40 offen lds
    s_add_u32 m0, s60, 134144
    s_nop 0
    buffer_load_dwordx4 v43, s[24:27], s40 offen lds
    s_add_u32 m0, s60, 135168
    s_nop 0
    buffer_load_dwordx4 v44, s[24:27], s40 offen lds
    s_add_u32 m0, s100, 151552
    s_nop 0
    buffer_load_dwordx4 v45, s[20:23], s101 offen lds
    s_add_u32 m0, s100, 152576
    s_nop 0
    buffer_load_dwordx4 v46, s[20:23], s101 offen lds
    s_waitcnt vmcnt(14)
    s_barrier
    s_add_u32 s62, s61, 2
    s_and_b32 s62, s62, 3
    s_add_u32 s63, s41, 0
    s_cmp_ge_u32 s63, 3
    s_cselect_b32 s46, 3, 0
    s_sub_u32 s63, s63, s46
    s_mul_i32 s40, s62, 245760
    s_mul_i32 s46, s63, 81920
    s_add_u32 s40, s40, s46
    s_mul_i32 s101, s62, 24576
    s_lshl_b32 s46, s63, 7
    s_add_u32 s101, s101, s46
    s_add_u32 m0, s60, 32768
    s_nop 0
    buffer_load_dwordx4 v40, s[24:27], s40 offen lds
    s_add_u32 m0, s60, 33792
    s_nop 0
    buffer_load_dwordx4 v41, s[24:27], s40 offen lds
    s_add_u32 m0, s60, 34816
    s_nop 0
    buffer_load_dwordx4 v42, s[24:27], s40 offen lds
    s_add_u32 m0, s60, 35840
    s_nop 0
    buffer_load_dwordx4 v43, s[24:27], s40 offen lds
    s_add_u32 m0, s60, 36864
    s_nop 0
    buffer_load_dwordx4 v44, s[24:27], s40 offen lds
    s_add_u32 m0, s100, 53248
    s_nop 0
    buffer_load_dwordx4 v45, s[20:23], s101 offen lds
    s_add_u32 m0, s100, 54272
    s_nop 0
    buffer_load_dwordx4 v46, s[20:23], s101 offen lds
    s_waitcnt vmcnt(14)
    s_barrier
    s_add_u32 s62, s61, 2
    s_and_b32 s62, s62, 3
    s_add_u32 s63, s41, 1
    s_cmp_ge_u32 s63, 3
    s_cselect_b32 s46, 3, 0
    s_sub_u32 s63, s63, s46
    s_mul_i32 s40, s62, 245760
    s_mul_i32 s46, s63, 81920
    s_add_u32 s40, s40, s46
    s_mul_i32 s101, s62, 24576
    s_lshl_b32 s46, s63, 7
    s_add_u32 s101, s101, s46
    s_add_u32 m0, s60, 65536
    s_nop 0
    buffer_load_dwordx4 v40, s[24:27], s40 offen lds
    s_add_u32 m0, s60, 66560
    s_nop 0
    buffer_load_dwordx4 v41, s[24:27], s40 offen lds
    s_add_u32 m0, s60, 67584
    s_nop 0
    buffer_load_dwordx4 v42, s[24:27], s40 offen lds
    s_add_u32 m0, s60, 68608
    s_nop 0
    buffer_load_dwordx4 v43, s[24:27], s40 offen lds
    s_add_u32 m0, s60, 69632
    s_nop 0
    buffer_load_dwordx4 v44, s[24:27], s40 offen lds
    s_add_u32 m0, s100, 86016
    s_nop 0
    buffer_load_dwordx4 v45, s[20:23], s101 offen lds
    s_add_u32 m0, s100, 87040
    s_nop 0
    buffer_load_dwordx4 v46, s[20:23], s101 offen lds
    s_waitcnt vmcnt(14)
    s_barrier
    s_cmp_lg_u32 s98, 0
    s_cbranch_scc1 L_16
    s_lshl_b32 s62, s4, 5
    v_mov_b32 v16, s62
    buffer_load_dword v15, v16, s[36:39], 0 offen offset:0 sc1
L_16:
    s_add_u32 s62, s61, 2
    s_and_b32 s62, s62, 3
    s_add_u32 s63, s41, 2
    s_cmp_ge_u32 s63, 3
    s_cselect_b32 s46, 3, 0
    s_sub_u32 s63, s63, s46
    s_mul_i32 s40, s62, 245760
    s_mul_i32 s46, s63, 81920
    s_add_u32 s40, s40, s46
    s_mul_i32 s101, s62, 24576
    s_lshl_b32 s46, s63, 7
    s_add_u32 s101, s101, s46
    s_add_u32 m0, s60, 98304
    s_nop 0
    buffer_load_dwordx4 v40, s[24:27], s40 offen lds
    s_add_u32 m0, s60, 99328
    s_nop 0
    buffer_load_dwordx4 v41, s[24:27], s40 offen lds
    s_add_u32 m0, s60, 100352
    s_nop 0
    buffer_load_dwordx4 v42, s[24:27], s40 offen lds
    s_add_u32 m0, s60, 101376
    s_nop 0
    buffer_load_dwordx4 v43, s[24:27], s40 offen lds
    s_add_u32 m0, s60, 102400
    s_nop 0
    buffer_load_dwordx4 v44, s[24:27], s40 offen lds
    s_add_u32 m0, s100, 118784
    s_nop 0
    buffer_load_dwordx4 v45, s[20:23], s101 offen lds
    s_add_u32 m0, s100, 119808
    s_nop 0
    buffer_load_dwordx4 v46, s[20:23], s101 offen lds
    s_waitcnt vmcnt(14)
    s_barrier
    s_cmp_lg_u32 s98, 0
    s_cbranch_scc1 L_17
    s_waitcnt vmcnt(7)
    s_mov_b32 s48, 0
L_18:
    v_readfirstlane_b32 s62, v15
    s_cmp_ge_u32 s62, 32
    s_cbranch_scc1 L_19
    s_add_u32 s48, s48, 1
    s_cmp_gt_u32 s48, 200000
    s_cbranch_scc1 L_19
    s_sleep 2
    buffer_load_dword v15, v16, s[36:39], 0 offen offset:0 sc1
    s_waitcnt vmcnt(0)
    s_branch L_18
L_19:
L_17:
    s_add_u32 s62, s61, 3
    s_and_b32 s62, s62, 3
    s_add_u32 s63, s41, 0
    s_cmp_ge_u32 s63, 3
    s_cselect_b32 s46, 3, 0
    s_sub_u32 s63, s63, s46
    s_mul_i32 s40, s62, 245760
    s_mul_i32 s46, s63, 81920
    s_add_u32 s40, s40, s46
    s_mul_i32 s101, s62, 24576
    s_lshl_b32 s46, s63, 7
    s_add_u32 s101, s101, s46
    s_add_u32 m0, s60, 0
    s_nop 0
    buffer_load_dwordx4 v40, s[24:27], s40 offen lds
    s_add_u32 m0, s60, 1024
    s_nop 0
    buffer_load_dwordx4 v41, s[24:27], s40 offen lds
    s_add_u32 m0, s60, 2048
    s_nop 0
    buffer_load_dwordx4 v42, s[24:27], s40 offen lds
    s_add_u32 m0, s60, 3072
    s_nop 0
    buffer_load_dwordx4 v43, s[24:27], s40 offen lds
    s_add_u32 m0, s60, 4096
    s_nop 0
    buffer_load_dwordx4 v44, s[24:27], s40 offen lds
    s_add_u32 m0, s100, 20480
    s_nop 0
    buffer_load_dwordx4 v45, s[20:23], s101 offen lds
    s_add_u32 m0, s100, 21504
    s_nop 0
    buffer_load_dwordx4 v46, s[20:23], s101 offen lds
    s_waitcnt vmcnt(14)
    s_barrier
    s_add_u32 s62, s61, s98
    s_and_b32 s62, s62, 3
    s_lshl_b32 s62, s62, 7
    s_add_u32 s56, s62, s43
    v_lshlrev_b32 v18, 2, v1
    buffer_load_dword v17, v18, s[28:31], s56 offen sc1
    s_add_u32 s62, s61, 3
    s_and_b32 s62, s62, 3
    s_add_u32 s63, s41, 1
    s_cmp_ge_u32 s63, 3
    s_cselect_b32 s46, 3, 0
    s_sub_u32 s63, s63, s46
    s_mul_i32 s40, s62, 245760
    s_mul_i32 s46, s63, 81920
    s_add_u32 s40, s40, s46
    s_mul_i32 s101, s62, 24576
    s_lshl_b32 s46, s63, 7
    s_add_u32 s101, s101, s46
    s_add_u32 m0, s60, 131072
    s_nop 0
    buffer_load_dwordx4 v40, s[24:27], s40 offen lds
    s_add_u32 m0, s60, 132096
    s_nop 0
    buffer_load_dwordx4 v41, s[24:27], s40 offen lds
    s_add_u32 m0, s60, 133120
    s_nop 0
    buffer_load_dwordx4 v42, s[24:27], s40 offen lds
    s_add_u32 m0, s60, 134144
    s_nop 0
    buffer_load_dwordx4 v43, s[24:27], s40 offen lds
    s_add_u32 m0, s60, 135168
    s_nop 0
    buffer_load_dwordx4 v44, s[24:27], s40 offen lds
    s_add_u32 m0, s100, 151552
    s_nop 0
    buffer_load_dwordx4 v45, s[20:23], s101 offen lds
    s_add_u32 m0, s100, 152576
    s_nop 0
    buffer_load_dwordx4 v46, s[20:23], s101 offen lds
    s_waitcnt vmcnt(15)
    s_barrier
    s_add_u32 s62, s61, 3
    s_and_b32 s62, s62, 3
    s_add_u32 s63, s41, 2
    s_cmp_ge_u32 s63, 3
    s_cselect_b32 s46, 3, 0
    s_sub_u32 s63, s63, s46
    s_mul_i32 s40, s62, 245760
    s_mul_i32 s46, s63, 81920
    s_add_u32 s40, s40, s46
    s_mul_i32 s101, s62, 24576
    s_lshl_b32 s46, s63, 7
    s_add_u32 s101, s101, s46
    s_add_u32 m0, s60, 32768
    s_nop 0
    buffer_load_dwordx4 v40, s[24:27], s40 offen lds
    s_add_u32 m0, s60, 33792
    s_nop 0
    buffer_load_dwordx4 v41, s[24:27], s40 offen lds
    s_add_u32 m0, s60, 34816
    s_nop 0
    buffer_load_dwordx4 v42, s[24:27], s40 offen lds
    s_add_u32 m0, s60, 35840
    s_nop 0
    buffer_load_dwordx4 v43, s[24:27], s40 offen lds
    s_add_u32 m0, s60, 36864
    s_nop 0
    buffer_load_dwordx4 v44, s[24:27], s40 offen lds
    s_add_u32 m0, s100, 53248
    s_nop 0
    buffer_load_dwordx4 v45, s[20:23], s101 offen lds
    s_add_u32 m0, s100, 54272
    s_nop 0
    buffer_load_dwordx4 v46, s[20:23], s101 offen lds
    s_waitcnt vmcnt(15)
    s_barrier
    s_waitcnt vmcnt(14)
    s_mov_b32 s48, 0
    s_mov_b64 s[62:63], exec
    s_mov_b64 exec, 0xf
L_20:
    v_cmp_ne_u32 vcc, 1, v17
    s_cbranch_vccz L_21
    s_add_u32 s48, s48, 1
    s_cmp_gt_u32 s48, 200000
    s_cbranch_scc1 L_21
    buffer_load_dword v17, v18, s[28:31], s56 offen sc1
    s_waitcnt vmcnt(0)
    s_branch L_20
L_21:
    s_mov_b64 exec, s[62:63]
    s_lshl_b32 s62, s4, 5
    s_lshl_b32 s63, s5, 2
    s_add_u32 s47, s62, s63
    s_add_u32 s62, s61, s98
    s_and_b32 s62, s62, 3
    s_add_u32 s62, s62, s47
    s_lshl_b32 s62, s62, 13
    buffer_load_dwordx4 v[48:51], v10, s[28:31], s62 offen offset:0 sc1
    buffer_load_dwordx4 v[52:55], v10, s[28:31], s62 offen offset:1024 sc1
    buffer_load_dwordx4 v[56:59], v10, s[28:31], s62 offen offset:2048 sc1
    buffer_load_dwordx4 v[60:63], v10, s[28:31], s62 offen offset:3072 sc1
    s_add_u32 s62, s62, 4096
    buffer_load_dwordx4 v[64:67], v10, s[28:31], s62 offen offset:0 sc1
    buffer_load_dwordx4 v[68:71], v10, s[28:31], s62 offen offset:1024 sc1
    buffer_load_dwordx4 v[72:75], v10, s[28:31], s62 offen offset:2048 sc1
    buffer_load_dwordx4 v[76:79], v10, s[28:31], s62 offen offset:3072 sc1
    s_waitcnt vmcnt(15)
    s_barrier
    s_waitcnt vmcnt(8)
    s_barrier
    s_waitcnt vmcnt(0)
    s_lshl_b32 s62, s98, 13
    s_add_u32 s62, s62, 65536
    v_add_u32 v16, s62, v10
    ds_write_b128 v16, v[48:51] offset:0
    ds_write_b128 v16, v[52:55] offset:1024
    ds_write_b128 v16, v[56:59] offset:2048
    ds_write_b128 v16, v[60:63] offset:3072
    ds_write_b128 v16, v[64:67] offset:4096
    ds_write_b128 v16, v[68:71] offset:5120
    ds_write_b128 v16, v[72:75] offset:6144
    ds_write_b128 v16, v[76:79] offset:7168
    s_waitcnt lgkmcnt(0)
    s_barrier
    s_barrier
    s_cmp_lg_u32 s3, 4
    s_cbranch_scc1 L_22
    s_mov_b32 s56, 4
    v_mul_u32_u24 v22, 1280, v12
    v_lshl_add_u32 v22, v13, 3, v22
    s_lshl_b32 s62, s56, 9
    s_add_u32 s47, s51, s62
    s_mov_b32 s48, 0
L_23:
    s_add_u32 s62, s47, 0
    buffer_load_dwordx2 v[48:49], v11, s[28:31], s62 offen sc1
    s_add_u32 s62, s47, 20480
    buffer_load_dwordx2 v[50:51], v11, s[28:31], s62 offen sc1
    s_add_u32 s62, s47, 40960
    buffer_load_dwordx2 v[52:53], v11, s[28:31], s62 offen sc1
    s_add_u32 s62, s47, 61440
    buffer_load_dwordx2 v[54:55], v11, s[28:31], s62 offen sc1
    s_add_u32 s62, s47, 81920
    buffer_load_dwordx2 v[56:57], v11, s[28:31], s62 offen sc1
    s_add_u32 s62, s47, 102400
    buffer_load_dwordx2 v[58:59], v11, s[28:31], s62 offen sc1
    s_add_u32 s62, s47, 122880
    buffer_load_dwordx2 v[60:61], v11, s[28:31], s62 offen sc1
    s_add_u32 s62, s47, 143360
    buffer_load_dwordx2 v[62:63], v11, s[28:31], s62 offen sc1
    s_waitcnt vmcnt(0)
    v_max3_u32 v14, v48, v49, v50
    v_max3_u32 v14, v14, v51, v52
    v_max3_u32 v14, v14, v53, v54
    v_max3_u32 v14, v14, v55, v56
    v_max3_u32 v14, v14, v57, v58
    v_max3_u32 v14, v14, v59, v60
    v_max3_u32 v14, v14, v61, v62
    v_max_u32 v14, v14, v63
    v_cmp_eq_u32 vcc, -1, v14
    s_cbranch_vccz L_24
    s_add_u32 s48, s48, 1
    s_cmp_gt_u32 s48, 200000
    s_cbranch_scc0 L_23
L_24:
    v_lshlrev_b32 v16, 16, v48
    v_and_b32 v17, 0xffff0000, v48
    v_lshlrev_b32 v18, 16, v49
    v_and_b32 v19, 0xffff0000, v49
    v_lshlrev_b32 v20, 16, v50
    v_and_b32 v21, 0xffff0000, v50
    v_add_f32 v16, v16, v20
    v_add_f32 v17, v17, v21
    v_lshlrev_b32 v20, 16, v51
    v_and_b32 v21, 0xffff0000, v51
    v_add_f32 v18, v18, v20
    v_add_f32 v19, v19, v21
    v_lshlrev_b32 v20, 16, v52
    v_and_b32 v21, 0xffff0000, v52
    v_add_f32 v16, v16, v20
    v_add_f32 v17, v17, v21
    v_lshlrev_b32 v20, 16, v53
    v_and_b32 v21, 0xffff0000, v53
    v_add_f32 v18, v18, v20
    v_add_f32 v19, v19, v21
    v_lshlrev_b32 v20, 16, v54
    v_and_b32 v21, 0xffff0000, v54
    v_add_f32 v16, v16, v20
    v_add_f32 v17, v17, v21
    v_lshlrev_b32 v20, 16, v55
    v_and_b32 v21, 0xffff0000, v55
    v_add_f32 v18, v18, v20
    v_add_f32 v19, v19, v21
    v_lshlrev_b32 v20, 16, v56
    v_and_b32 v21, 0xffff0000, v56
    v_add_f32 v16, v16, v20
    v_add_f32 v17, v17, v21
    v_lshlrev_b32 v20, 16, v57
    v_and_b32 v21, 0xffff0000, v57
    v_add_f32 v18, v18, v20
    v_add_f32 v19, v19, v21
    v_lshlrev_b32 v20, 16, v58
    v_and_b32 v21, 0xffff0000, v58
    v_add_f32 v16, v16, v20
    v_add_f32 v17, v17, v21
    v_lshlrev_b32 v20, 16, v59
    v_and_b32 v21, 0xffff0000, v59
    v_add_f32 v18, v18, v20
    v_add_f32 v19, v19, v21
    v_lshlrev_b32 v20, 16, v60
    v_and_b32 v21, 0xffff0000, v60
    v_add_f32 v16, v16, v20
    v_add_f32 v17, v17, v21
    v_lshlrev_b32 v20, 16, v61
    v_and_b32 v21, 0xffff0000, v61
    v_add_f32 v18, v18, v20
    v_add_f32 v19, v19, v21
    v_lshlrev_b32 v20, 16, v62
    v_and_b32 v21, 0xffff0000, v62
    v_add_f32 v16, v16, v20
    v_add_f32 v17, v17, v21
    v_lshlrev_b32 v20, 16, v63
    v_and_b32 v21, 0xffff0000, v63
    v_add_f32 v18, v18, v20
    v_add_f32 v19, v19, v21
    v_cvt_pk_bf16_f32 v20, v16, v17
    v_cvt_pk_bf16_f32 v21, v18, v19
    s_lshl_b32 s62, s56, 5
    s_add_u32 s62, s62, s52
    buffer_store_dwordx2 v[20:21], v22, s[32:35], s62 offen
L_22:
    s_endpgm
L_var2:
    v_lshlrev_b32 v3, 4, v9
    v_add_u32 v4, 0, v1
    v_mul_u32_u24 v5, 2731, v4
    v_lshrrev_b32 v5, 16, v5
    v_mul_u32_u24 v6, 24, v5
    v_sub_u32 v6, v4, v6
    v_bfe_u32 v7, v5, 1, 1
    v_lshlrev_b32 v7, 1, v7
    v_xor_b32 v6, v6, v7
    v_add_u32 v5, v5, v3
    v_mul_u32_u24 v5, 12288, v5
    v_lshl_add_u32 v24, v6, 4, v5
    v_add_u32 v27, 98304, v24
    v_xor_b32 v27, 64, v27
    v_add_u32 v4, 64, v1
    v_mul_u32_u24 v5, 2731, v4
    v_lshrrev_b32 v5, 16, v5
    v_mul_u32_u24 v6, 24, v5
    v_sub_u32 v6, v4, v6
    v_bfe_u32 v7, v5, 1, 1
    v_lshlrev_b32 v7, 1, v7
    v_xor_b32 v6, v6, v7
    v_add_u32 v5, v5, v3
    v_mul_u32_u24 v5, 12288, v5
    v_lshl_add_u32 v25, v6, 4, v5
    v_add_u32 v28, 98304, v25
    v_xor_b32 v28, 64, v28
    v_add_u32 v4, 128, v1
    v_mul_u32_u24 v5, 2731, v4
    v_lshrrev_b32 v5, 16, v5
    v_mul_u32_u24 v6, 24, v5
    v_sub_u32 v6, v4, v6
    v_bfe_u32 v7, v5, 1, 1
    v_lshlrev_b32 v7, 1, v7
    v_xor_b32 v6, v6, v7
    v_add_u32 v5, v5, v3
    v_mul_u32_u24 v5, 12288, v5
    v_lshl_add_u32 v26, v6, 4, v5
    v_add_u32 v29, 98304, v26
    v_xor_b32 v29, 64, v29
    v_lshrrev_b32 v5, 3, v1
    v_and_b32 v6, 7, v1
    v_lshrrev_b32 v7, 1, v5
    v_xor_b32 v6, v6, v7
    v_add_u32 v5, v5, v3
    v_mul_u32_u24 v7, 1280, v5
    v_lshl_add_u32 v30, v6, 4, v7
    v_add_u32 v31, 10240, v30
    v_xor_b32 v31, 64, v31
    v_mul_u32_u24 v7, 384, v5
    v_lshl_add_u32 v45, v6, 4, v7
    v_add_u32 v46, 3072, v45
    v_xor_b32 v46, 64, v46
    s_mul_i32 s59, s98, 6144
    s_mul_i32 s60, s98, 5120
    s_mov_b32 s56, s4
    s_mul_i32 s62, s4, 81920
    s_mul_i32 s63, s7, 384
    s_waitcnt lgkmcnt(0)
    s_add_u32 s8, s40, s62
    s_addc_u32 s9, s41, 0
    s_mov_b32 s10, 81920
    s_mov_b32 s11, 0x00020000
    s_add_u32 s12, s46, s63
    s_addc_u32 s13, s47, 0
    s_mov_b32 s14, 7852416
    s_mov_b32 s15, 0x00020000
    s_mul_i32 s57, s56, 786432
    s_lshl_b32 s58, s56, 7
    s_add_u32 m0, s59, 0
    s_nop 0
    buffer_load_dwordx4 v24, s[12:15], s57 offen lds
    s_add_u32 m0, s59, 1024
    s_nop 0
    buffer_load_dwordx4 v25, s[12:15], s57 offen lds
    s_add_u32 m0, s59, 2048
    s_nop 0
    buffer_load_dwordx4 v26, s[12:15], s57 offen lds
    s_add_u32 m0, s59, 3072
    s_nop 0
    buffer_load_dwordx4 v27, s[12:15], s57 offen lds
    s_add_u32 m0, s59, 4096
    s_nop 0
    buffer_load_dwordx4 v28, s[12:15], s57 offen lds
    s_add_u32 m0, s59, 5120
    s_nop 0
    buffer_load_dwordx4 v29, s[12:15], s57 offen lds
    s_add_u32 m0, s100, 24576
    s_nop 0
    buffer_load_dwordx4 v30, s[8:11], s58 offen lds
    s_add_u32 m0, s100, 25600
    s_nop 0
    buffer_load_dwordx4 v31, s[8:11], s58 offen lds
    s_add_u32 s56, s56, 1
    s_cmp_ge_u32 s56, 10
    s_cselect_b32 s56, 0, s56
    v_and_b32 v12, 15, v1
    v_lshrrev_b32 v13, 4, v1
    v_lshlrev_b32 v10, 4, v1
    v_lshlrev_b32 v11, 3, v1
    s_mul_i32 s62, s6, 160
    s_mul_i32 s63, s98, 40
    s_add_u32 s62, s62, s63
    v_min_u32 v4, 39, v1
    v_add_u32 v4, s62, v4
    v_lshlrev_b32 v19, 7, v4
    s_mul_i32 s62, s4, 48
    s_mul_i32 s63, s98, 12
    s_add_u32 s62, s62, s63
    v_min_u32 v4, 11, v1
    v_add_u32 v4, s62, v4
    v_mul_u32_u24 v5, 21846, v4
    v_lshrrev_b32 v5, 16, v5
    v_mul_u32_u24 v6, 3, v5
    v_sub_u32 v6, v4, v6
    v_add_u32 v5, 512, v5
    v_mul_u32_u24 v5, 12288, v5
    v_lshl_add_u32 v20, v6, 7, v5
    buffer_load_dword v80, v19, s[8:11], 0 offen
    buffer_load_dword v81, v20, s[12:15], 0 offen
    s_lshl_b32 s62, s4, 5
    s_add_u32 s63, s62, s7
    s_mul_i32 s63, s63, 24576
    s_add_u32 s16, s42, s63
    s_addc_u32 s17, s43, 0
    s_mov_b32 s18, 24576
    s_mov_b32 s19, 0x00020000
    s_lshl_b32 s63, s5, 2
    s_add_u32 s63, s63, s62
    s_mul_i32 s63, s63, 24576
    s_add_u32 s20, s44, s63
    s_addc_u32 s21, s45, 0
    s_mov_b32 s22, 98304
    s_mov_b32 s23, 0x00020000
    s_mul_i32 s62, s5, 983040
    s_mul_i32 s63, s6, 320
    s_add_u32 s62, s62, s63
    s_add_u32 s24, s48, s62
    s_addc_u32 s25, s49, 0
    s_mov_b32 s26, 982080
    s_mov_b32 s27, 0x00020000
    s_mov_b32 s32, s50
    s_mov_b32 s33, s51
    s_mov_b32 s34, 655360
    s_mov_b32 s35, 0x00020000
    s_mov_b32 s36, s52
    s_mov_b32 s37, s53
    s_mov_b32 s38, 256
    s_mov_b32 s39, 0x00020000
    s_mov_b32 s28, s54
    s_mov_b32 s29, s55
    s_mov_b32 s30, 268435456
    s_mov_b32 s31, 0x00020000
    s_lshl_b32 s62, s4, 5
    s_add_u32 s62, s62, s7
    s_lshl_b32 s45, s62, 13
    s_lshl_b32 s63, s62, 7
    s_add_u32 s53, s63, 8388608
    s_lshl_b32 s62, s4, 5
    s_lshl_b32 s63, s5, 2
    s_add_u32 s63, s63, s62
    s_lshl_b32 s63, s63, 7
    s_add_u32 s43, s63, 8388608
    s_lshl_b32 s62, s4, 2
    s_add_u32 s62, s62, s6
    s_lshl_b32 s63, s62, 3
    s_add_u32 s63, s63, s5
    s_mul_i32 s63, s63, 20480
    s_add_u32 s63, s63, 2097152
    s_mul_i32 s50, s98, 5120
    s_add_u32 s50, s50, s63
    s_mul_i32 s62, s62, 163840
    s_mul_i32 s63, s5, 2560
    s_add_u32 s62, s62, s63
    s_add_u32 s51, s62, 2097152
    s_lshr_b32 s62, s5, 2
    s_lshl_b32 s62, s62, 1
    s_and_b32 s63, s5, 1
    s_add_u32 s62, s62, s63
    s_lshl_b32 s62, s62, 4
    s_lshl_b32 s63, s4, 6
    s_add_u32 s62, s62, s63
    s_mul_i32 s62, s62, 1280
    s_mul_i32 s63, s6, 320
    s_add_u32 s62, s62, s63
    s_lshr_b32 s63, s5, 1
    s_and_b32 s63, s63, 1
    s_mul_i32 s63, s63, 160
    s_add_u32 s52, s62, s63
    s_mov_b32 s49, 0xfffffffe
    s_lshl_b32 s62, s4, 5
    s_add_u32 s62, s62, s6
    s_lshl_b32 s62, s62, 7
    s_add_u32 s42, s62, 8388608
    s_lshr_b32 s62, s4, 1
    s_add_u32 s62, s62, s6
    s_and_b32 s61, s62, 3
    s_and_b32 s62, s4, 1
    s_lshl_b32 s41, s62, 1
    v_add_u32 v4, 0, v1
    v_mul_u32_u24 v5, 2731, v4
    v_lshrrev_b32 v5, 16, v5
    v_mul_u32_u24 v6, 24, v5
    v_sub_u32 v6, v4, v6
    v_bfe_u32 v7, v5, 1, 3
    v_xor_b32 v6, v6, v7
    v_add_u32 v5, v5, v3
    v_mul_u32_u24 v5, 384, v5
    v_lshl_add_u32 v32, v6, 4, v5
    v_add_u32 v4, 64, v1
    v_mul_u32_u24 v5, 2731, v4
    v_lshrrev_b32 v5, 16, v5
    v_mul_u32_u24 v6, 24, v5
    v_sub_u32 v6, v4, v6
    v_bfe_u32 v7, v5, 1, 3
    v_xor_b32 v6, v6, v7
    v_add_u32 v5, v5, v3
    v_mul_u32_u24 v5, 384, v5
    v_lshl_add_u32 v33, v6, 4, v5
    v_add_u32 v4, 128, v1
    v_mul_u32_u24 v5, 2731, v4
    v_lshrrev_b32 v5, 16, v5
    v_mul_u32_u24 v6, 24, v5
    v_sub_u32 v6, v4, v6
    v_bfe_u32 v7, v5, 1, 3
    v_xor_b32 v6, v6, v7
    v_add_u32 v5, v5, v3
    v_mul_u32_u24 v5, 384, v5
    v_lshl_add_u32 v34, v6, 4, v5
    v_add_u32 v4, 192, v1
    v_mul_u32_u24 v5, 2731, v4
    v_lshrrev_b32 v5, 16, v5
    v_mul_u32_u24 v6, 24, v5
    v_sub_u32 v6, v4, v6
    v_bfe_u32 v7, v5, 1, 3
    v_xor_b32 v6, v6, v7
    v_add_u32 v5, v5, v3
    v_mul_u32_u24 v5, 384, v5
    v_lshl_add_u32 v35, v6, 4, v5
    v_add_u32 v4, 256, v1
    v_mul_u32_u24 v5, 2731, v4
    v_lshrrev_b32 v5, 16, v5
    v_mul_u32_u24 v6, 24, v5
    v_sub_u32 v6, v4, v6
    v_bfe_u32 v7, v5, 1, 3
    v_xor_b32 v6, v6, v7
    v_add_u32 v5, v5, v3
    v_mul_u32_u24 v5, 384, v5
    v_lshl_add_u32 v36, v6, 4, v5
    v_add_u32 v4, 320, v1
    v_mul_u32_u24 v5, 2731, v4
    v_lshrrev_b32 v5, 16, v5
    v_mul_u32_u24 v6, 24, v5
    v_sub_u32 v6, v4, v6
    v_bfe_u32 v7, v5, 1, 3
    v_xor_b32 v6, v6, v7
    v_add_u32 v5, v5, v3
    v_mul_u32_u24 v5, 384, v5
    v_lshl_add_u32 v37, v6, 4, v5
    v_add_u32 v4, 0, v1
    v_mul_u32_u24 v5, 3277, v4
    v_lshrrev_b32 v5, 16, v5
    v_mul_u32_u24 v6, 20, v5
    v_sub_u32 v6, v4, v6
    v_bfe_u32 v7, v5, 3, 1
    v_lshlrev_b32 v7, 1, v7
    v_xor_b32 v6, v6, v7
    v_add_u32 v5, v5, v3
    v_mul_u32_u24 v5, 1280, v5
    v_lshl_add_u32 v40, v6, 4, v5
    v_add_u32 v4, 64, v1
    v_mul_u32_u24 v5, 3277, v4
    v_lshrrev_b32 v5, 16, v5
    v_mul_u32_u24 v6, 20, v5
    v_sub_u32 v6, v4, v6
    v_bfe_u32 v7, v5, 3, 1
    v_lshlrev_b32 v7, 1, v7
    v_xor_b32 v6, v6, v7
    v_add_u32 v5, v5, v3
    v_mul_u32_u24 v5, 1280, v5
    v_lshl_add_u32 v41, v6, 4, v5
    v_add_u32 v4, 128, v1
    v_mul_u32_u24 v5, 3277, v4
    v_lshrrev_b32 v5, 16, v5
    v_mul_u32_u24 v6, 20, v5
    v_sub_u32 v6, v4, v6
    v_bfe_u32 v7, v5, 3, 1
    v_lshlrev_b32 v7, 1, v7
    v_xor_b32 v6, v6, v7
    v_add_u32 v5, v5, v3
    v_mul_u32_u24 v5, 1280, v5
    v_lshl_add_u32 v42, v6, 4, v5
    v_add_u32 v4, 192, v1
    v_mul_u32_u24 v5, 3277, v4
    v_lshrrev_b32 v5, 16, v5
    v_mul_u32_u24 v6, 20, v5
    v_sub_u32 v6, v4, v6
    v_bfe_u32 v7, v5, 3, 1
    v_lshlrev_b32 v7, 1, v7
    v_xor_b32 v6, v6, v7
    v_add_u32 v5, v5, v3
    v_mul_u32_u24 v5, 1280, v5
    v_lshl_add_u32 v43, v6, 4, v5
    v_add_u32 v4, 256, v1
    v_mul_u32_u24 v5, 3277, v4
    v_lshrrev_b32 v5, 16, v5
    v_mul_u32_u24 v6, 20, v5
    v_sub_u32 v6, v4, v6
    v_bfe_u32 v7, v5, 3, 1
    v_lshlrev_b32 v7, 1, v7
    v_xor_b32 v6, v6, v7
    v_add_u32 v5, v5, v3
    v_mul_u32_u24 v5, 1280, v5
    v_lshl_add_u32 v44, v6, 4, v5
    v_mov_b32 v16, 0
    v_mov_b32 v22, 0
    v_mov_b32 v84, -1
    v_mov_b32 v85, -1
    v_mov_b32 v86, -1
    v_mov_b32 v87, -1
    s_mul_i32 s57, s56, 786432
    s_lshl_b32 s58, s56, 7
    s_add_u32 m0, s59, 32768
    s_nop 0
    buffer_load_dwordx4 v24, s[12:15], s57 offen lds
    s_add_u32 m0, s59, 33792
    s_nop 0
    buffer_load_dwordx4 v25, s[12:15], s57 offen lds
    s_add_u32 m0, s59, 34816
    s_nop 0
    buffer_load_dwordx4 v26, s[12:15], s57 offen lds
    s_add_u32 m0, s59, 35840
    s_nop 0
    buffer_load_dwordx4 v27, s[12:15], s57 offen lds
    s_add_u32 m0, s59, 36864
    s_nop 0
    buffer_load_dwordx4 v28, s[12:15], s57 offen lds
    s_add_u32 m0, s59, 37888
    s_nop 0
    buffer_load_dwordx4 v29, s[12:15], s57 offen lds
    s_add_u32 m0, s100, 57344
    s_nop 0
    buffer_load_dwordx4 v30, s[8:11], s58 offen lds
    s_add_u32 m0, s100, 58368
    s_nop 0
    buffer_load_dwordx4 v31, s[8:11], s58 offen lds
    s_add_u32 s56, s56, 1
    s_cmp_ge_u32 s56, 10
    s_cselect_b32 s56, 0, s56
    s_waitcnt vmcnt(10)
    s_barrier
    s_mul_i32 s57, s56, 786432
    s_lshl_b32 s58, s56, 7
    s_add_u32 m0, s59, 65536
    s_nop 0
    buffer_load_dwordx4 v24, s[12:15], s57 offen lds
    s_add_u32 m0, s59, 66560
    s_nop 0
    buffer_load_dwordx4 v25, s[12:15], s57 offen lds
    s_add_u32 m0, s59, 67584
    s_nop 0
    buffer_load_dwordx4 v26, s[12:15], s57 offen lds
    s_add_u32 m0, s59, 68608
    s_nop 0
    buffer_load_dwordx4 v27, s[12:15], s57 offen lds
    s_add_u32 m0, s59, 69632
    s_nop 0
    buffer_load_dwordx4 v28, s[12:15], s57 offen lds
    s_add_u32 m0, s59, 70656
    s_nop 0
    buffer_load_dwordx4 v29, s[12:15], s57 offen lds
    s_add_u32 m0, s100, 90112
    s_nop 0
    buffer_load_dwordx4 v30, s[8:11], s58 offen lds
    s_add_u32 m0, s100, 91136
    s_nop 0
    buffer_load_dwordx4 v31, s[8:11], s58 offen lds
    s_add_u32 s56, s56, 1
    s_cmp_ge_u32 s56, 10
    s_cselect_b32 s56, 0, s56
    s_waitcnt vmcnt(8)
    s_barrier
    s_mul_i32 s57, s56, 786432
    s_lshl_b32 s58, s56, 7
    s_add_u32 m0, s59, 0
    s_nop 0
    buffer_load_dwordx4 v24, s[12:15], s57 offen lds
    s_add_u32 m0, s59, 1024
    s_nop 0
    buffer_load_dwordx4 v25, s[12:15], s57 offen lds
    s_add_u32 m0, s59, 2048
    s_nop 0
    buffer_load_dwordx4 v26, s[12:15], s57 offen lds
    s_add_u32 m0, s59, 3072
    s_nop 0
    buffer_load_dwordx4 v27, s[12:15], s57 offen lds
    s_add_u32 m0, s59, 4096
    s_nop 0
    buffer_load_dwordx4 v28, s[12:15], s57 offen lds
    s_add_u32 m0, s59, 5120
    s_nop 0
    buffer_load_dwordx4 v29, s[12:15], s57 offen lds
    s_add_u32 m0, s100, 24576
    s_nop 0
    buffer_load_dwordx4 v30, s[8:11], s58 offen lds
    s_add_u32 m0, s100, 25600
    s_nop 0
    buffer_load_dwordx4 v31, s[8:11], s58 offen lds
    s_add_u32 s56, s56, 1
    s_cmp_ge_u32 s56, 10
    s_cselect_b32 s56, 0, s56
    s_cmp_lg_u32 s98, 0
    s_cbranch_scc1 L_25
    v_lshlrev_b32 v4, 2, v1
    v_mov_b32 v5, 0
    s_mov_b64 s[62:63], exec
    s_mov_b64 exec, 0xff
    buffer_store_dword v5, v4, s[28:31], s53 offen sc1
    s_mov_b64 exec, s[62:63]
L_25:
    s_add_u32 s63, s50, 0
    buffer_store_dwordx4 v[84:87], v10, s[28:31], s63 offen sc1
    s_waitcnt vmcnt(8)
    s_barrier
    s_mul_i32 s57, s56, 786432
    s_lshl_b32 s58, s56, 7
    s_add_u32 m0, s59, 32768
    s_nop 0
    buffer_load_dwordx4 v24, s[12:15], s57 offen lds
    s_add_u32 m0, s59, 33792
    s_nop 0
    buffer_load_dwordx4 v25, s[12:15], s57 offen lds
    s_add_u32 m0, s59, 34816
    s_nop 0
    buffer_load_dwordx4 v26, s[12:15], s57 offen lds
    s_add_u32 m0, s59, 35840
    s_nop 0
    buffer_load_dwordx4 v27, s[12:15], s57 offen lds
    s_add_u32 m0, s59, 36864
    s_nop 0
    buffer_load_dwordx4 v28, s[12:15], s57 offen lds
    s_add_u32 m0, s59, 37888
    s_nop 0
    buffer_load_dwordx4 v29, s[12:15], s57 offen lds
    s_add_u32 m0, s100, 57344
    s_nop 0
    buffer_load_dwordx4 v30, s[8:11], s58 offen lds
    s_add_u32 m0, s100, 58368
    s_nop 0
    buffer_load_dwordx4 v31, s[8:11], s58 offen lds
    s_add_u32 s56, s56, 1
    s_cmp_ge_u32 s56, 10
    s_cselect_b32 s56, 0, s56
    s_add_u32 s63, s50, 1024
    buffer_store_dwordx4 v[84:87], v10, s[28:31], s63 offen sc1
    s_waitcnt vmcnt(8)
    s_barrier
    s_mul_i32 s57, s56, 786432
    s_lshl_b32 s58, s56, 7
    s_add_u32 m0, s59, 65536
    s_nop 0
    buffer_load_dwordx4 v24, s[12:15], s57 offen lds
    s_add_u32 m0, s59, 66560
    s_nop 0
    buffer_load_dwordx4 v25, s[12:15], s57 offen lds
    s_add_u32 m0, s59, 67584
    s_nop 0
    buffer_load_dwordx4 v26, s[12:15], s57 offen lds
    s_add_u32 m0, s59, 68608
    s_nop 0
    buffer_load_dwordx4 v27, s[12:15], s57 offen lds
    s_add_u32 m0, s59, 69632
    s_nop 0
    buffer_load_dwordx4 v28, s[12:15], s57 offen lds
    s_add_u32 m0, s59, 70656
    s_nop 0
    buffer_load_dwordx4 v29, s[12:15], s57 offen lds
    s_add_u32 m0, s100, 90112
    s_nop 0
    buffer_load_dwordx4 v30, s[8:11], s58 offen lds
    s_add_u32 m0, s100, 91136
    s_nop 0
    buffer_load_dwordx4 v31, s[8:11], s58 offen lds
    s_add_u32 s56, s56, 1
    s_cmp_ge_u32 s56, 10
    s_cselect_b32 s56, 0, s56
    s_add_u32 m0, s59, 131072
    s_nop 0
    buffer_load_dwordx4 v32, s[16:19], 0 offen nt lds
    s_add_u32 m0, s59, 132096
    s_nop 0
    buffer_load_dwordx4 v33, s[16:19], 0 offen nt lds
    s_add_u32 m0, s59, 133120
    s_nop 0
    buffer_load_dwordx4 v34, s[16:19], 0 offen nt lds
    s_add_u32 m0, s59, 134144
    s_nop 0
    buffer_load_dwordx4 v35, s[16:19], 0 offen nt lds
    s_add_u32 m0, s59, 135168
    s_nop 0
    buffer_load_dwordx4 v36, s[16:19], 0 offen nt lds
    s_add_u32 m0, s59, 136192
    s_nop 0
    buffer_load_dwordx4 v37, s[16:19], 0 offen nt lds
    s_add_u32 s63, s50, 2048
    buffer_store_dwordx4 v[84:87], v10, s[28:31], s63 offen sc1
    s_waitcnt vmcnt(14)
    s_barrier
    s_mul_i32 s57, s56, 786432
    s_lshl_b32 s58, s56, 7
    s_add_u32 m0, s59, 0
    s_nop 0
    buffer_load_dwordx4 v24, s[12:15], s57 offen lds
    s_add_u32 m0, s59, 1024
    s_nop 0
    buffer_load_dwordx4 v25, s[12:15], s57 offen lds
    s_add_u32 m0, s59, 2048
    s_nop 0
    buffer_load_dwordx4 v26, s[12:15], s57 offen lds
    s_add_u32 m0, s59, 3072
    s_nop 0
    buffer_load_dwordx4 v27, s[12:15], s57 offen lds
    s_add_u32 m0, s59, 4096
    s_nop 0
    buffer_load_dwordx4 v28, s[12:15], s57 offen lds
    s_add_u32 m0, s59, 5120
    s_nop 0
    buffer_load_dwordx4 v29, s[12:15], s57 offen lds
    s_add_u32 m0, s100, 24576
    s_nop 0
    buffer_load_dwordx4 v30, s[8:11], s58 offen lds
    s_add_u32 m0, s100, 25600
    s_nop 0
    buffer_load_dwordx4 v31, s[8:11], s58 offen lds
    s_add_u32 s56, s56, 1
    s_cmp_ge_u32 s56, 10
    s_cselect_b32 s56, 0, s56
    s_add_u32 s63, s50, 3072
    buffer_store_dwordx4 v[84:87], v10, s[28:31], s63 offen sc1
    s_waitcnt vmcnt(14)
    s_barrier
    s_mul_i32 s57, s56, 786432
    s_lshl_b32 s58, s56, 7
    s_add_u32 m0, s59, 32768
    s_nop 0
    buffer_load_dwordx4 v24, s[12:15], s57 offen lds
    s_add_u32 m0, s59, 33792
    s_nop 0
    buffer_load_dwordx4 v25, s[12:15], s57 offen lds
    s_add_u32 m0, s59, 34816
    s_nop 0
    buffer_load_dwordx4 v26, s[12:15], s57 offen lds
    s_add_u32 m0, s59, 35840
    s_nop 0
    buffer_load_dwordx4 v27, s[12:15], s57 offen lds
    s_add_u32 m0, s59, 36864
    s_nop 0
    buffer_load_dwordx4 v28, s[12:15], s57 offen lds
    s_add_u32 m0, s59, 37888
    s_nop 0
    buffer_load_dwordx4 v29, s[12:15], s57 offen lds
    s_add_u32 m0, s100, 57344
    s_nop 0
    buffer_load_dwordx4 v30, s[8:11], s58 offen lds
    s_add_u32 m0, s100, 58368
    s_nop 0
    buffer_load_dwordx4 v31, s[8:11], s58 offen lds
    s_add_u32 s56, s56, 1
    s_cmp_ge_u32 s56, 10
    s_cselect_b32 s56, 0, s56
    s_add_u32 s63, s50, 4096
    buffer_store_dwordx4 v[84:87], v10, s[28:31], s63 offen sc1
    s_waitcnt vmcnt(8)
    s_waitcnt vmcnt(16)
    s_barrier
    s_mul_i32 s57, s56, 786432
    s_lshl_b32 s58, s56, 7
    s_add_u32 m0, s59, 65536
    s_nop 0
    buffer_load_dwordx4 v24, s[12:15], s57 offen lds
    s_add_u32 m0, s59, 66560
    s_nop 0
    buffer_load_dwordx4 v25, s[12:15], s57 offen lds
    s_add_u32 m0, s59, 67584
    s_nop 0
    buffer_load_dwordx4 v26, s[12:15], s57 offen lds
    s_add_u32 m0, s59, 68608
    s_nop 0
    buffer_load_dwordx4 v27, s[12:15], s57 offen lds
    s_add_u32 m0, s59, 69632
    s_nop 0
    buffer_load_dwordx4 v28, s[12:15], s57 offen lds
    s_add_u32 m0, s59, 70656
    s_nop 0
    buffer_load_dwordx4 v29, s[12:15], s57 offen lds
    s_add_u32 m0, s100, 90112
    s_nop 0
    buffer_load_dwordx4 v30, s[8:11], s58 offen lds
    s_add_u32 m0, s100, 91136
    s_nop 0
    buffer_load_dwordx4 v31, s[8:11], s58 offen lds
    s_add_u32 s56, s56, 1
    s_cmp_ge_u32 s56, 10
    s_cselect_b32 s56, 0, s56
    s_waitcnt vmcnt(8)
    s_barrier
    s_mul_i32 s57, s56, 786432
    s_lshl_b32 s58, s56, 7
    s_add_u32 m0, s59, 0
    s_nop 0
    buffer_load_dwordx4 v24, s[12:15], s57 offen lds
    s_add_u32 m0, s59, 1024
    s_nop 0
    buffer_load_dwordx4 v25, s[12:15], s57 offen lds
    s_add_u32 m0, s59, 2048
    s_nop 0
    buffer_load_dwordx4 v26, s[12:15], s57 offen lds
    s_add_u32 m0, s59, 3072
    s_nop 0
    buffer_load_dwordx4 v27, s[12:15], s57 offen lds
    s_add_u32 m0, s59, 4096
    s_nop 0
    buffer_load_dwordx4 v28, s[12:15], s57 offen lds
    s_add_u32 m0, s59, 5120
    s_nop 0
    buffer_load_dwordx4 v29, s[12:15], s57 offen lds
    s_add_u32 m0, s100, 24576
    s_nop 0
    buffer_load_dwordx4 v30, s[8:11], s58 offen lds
    s_add_u32 m0, s100, 25600
    s_nop 0
    buffer_load_dwordx4 v31, s[8:11], s58 offen lds
    s_add_u32 s56, s56, 1
    s_cmp_ge_u32 s56, 10
    s_cselect_b32 s56, 0, s56
    s_add_u32 s62, s61, 0
    s_and_b32 s62, s62, 3
    s_add_u32 s63, s41, 0
    s_cmp_ge_u32 s63, 3
    s_cselect_b32 s46, 3, 0
    s_sub_u32 s63, s63, s46
    s_mul_i32 s40, s62, 245760
    s_mul_i32 s46, s63, 81920
    s_add_u32 s40, s40, s46
    s_mul_i32 s101, s62, 24576
    s_lshl_b32 s46, s63, 7
    s_add_u32 s101, s101, s46
    s_add_u32 m0, s60, 98304
    s_nop 0
    buffer_load_dwordx4 v40, s[24:27], s40 offen lds
    s_add_u32 m0, s60, 99328
    s_nop 0
    buffer_load_dwordx4 v41, s[24:27], s40 offen lds
    s_add_u32 m0, s60, 100352
    s_nop 0
    buffer_load_dwordx4 v42, s[24:27], s40 offen lds
    s_add_u32 m0, s60, 101376
    s_nop 0
    buffer_load_dwordx4 v43, s[24:27], s40 offen lds
    s_add_u32 m0, s60, 102400
    s_nop 0
    buffer_load_dwordx4 v44, s[24:27], s40 offen lds
    s_add_u32 m0, s100, 118784
    s_nop 0
    buffer_load_dwordx4 v45, s[20:23], s101 offen lds
    s_add_u32 m0, s100, 119808
    s_nop 0
    buffer_load_dwordx4 v46, s[20:23], s101 offen lds
    s_waitcnt vmcnt(15)
    s_barrier
    s_add_u32 s62, s61, 0
    s_and_b32 s62, s62, 3
    s_add_u32 s63, s41, 1
    s_cmp_ge_u32 s63, 3
    s_cselect_b32 s46, 3, 0
    s_sub_u32 s63, s63, s46
    s_mul_i32 s40, s62, 245760
    s_mul_i32 s46, s63, 81920
    s_add_u32 s40, s40, s46
    s_mul_i32 s101, s62, 24576
    s_lshl_b32 s46, s63, 7
    s_add_u32 s101, s101, s46
    s_add_u32 m0, s60, 32768
    s_nop 0
    buffer_load_dwordx4 v40, s[24:27], s40 offen lds
    s_add_u32 m0, s60, 33792
    s_nop 0
    buffer_load_dwordx4 v41, s[24:27], s40 offen lds
    s_add_u32 m0, s60, 34816
    s_nop 0
    buffer_load_dwordx4 v42, s[24:27], s40 offen lds
    s_add_u32 m0, s60, 35840
    s_nop 0
    buffer_load_dwordx4 v43, s[24:27], s40 offen lds
    s_add_u32 m0, s60, 36864
    s_nop 0
    buffer_load_dwordx4 v44, s[24:27], s40 offen lds
    s_add_u32 m0, s100, 53248
    s_nop 0
    buffer_load_dwordx4 v45, s[20:23], s101 offen lds
    s_add_u32 m0, s100, 54272
    s_nop 0
    buffer_load_dwordx4 v46, s[20:23], s101 offen lds
    s_add_u32 s62, s61, 0
    s_and_b32 s62, s62, 3
    s_add_u32 s63, s41, 2
    s_cmp_ge_u32 s63, 3
    s_cselect_b32 s46, 3, 0
    s_sub_u32 s63, s63, s46
    s_mul_i32 s40, s62, 245760
    s_mul_i32 s46, s63, 81920
    s_add_u32 s40, s40, s46
    s_mul_i32 s101, s62, 24576
    s_lshl_b32 s46, s63, 7
    s_add_u32 s101, s101, s46
    v_and_b32 v4, 15, v1
    v_add_u32 v4, v4, v3
    v_mul_u32_u24 v4, 384, v4
    buffer_load_dword v82, v4, s[20:23], s101 offen
    s_waitcnt vmcnt(15)
    s_barrier
    s_add_u32 s62, s61, 0
    s_and_b32 s62, s62, 3
    s_add_u32 s63, s41, 2
    s_cmp_ge_u32 s63, 3
    s_cselect_b32 s46, 3, 0
    s_sub_u32 s63, s63, s46
    s_mul_i32 s40, s62, 245760
    s_mul_i32 s46, s63, 81920
    s_add_u32 s40, s40, s46
    s_mul_i32 s101, s62, 24576
    s_lshl_b32 s46, s63, 7
    s_add_u32 s101, s101, s46
    s_add_u32 m0, s60, 65536
    s_nop 0
    buffer_load_dwordx4 v40, s[24:27], s40 offen lds
    s_add_u32 m0, s60, 66560
    s_nop 0
    buffer_load_dwordx4 v41, s[24:27], s40 offen lds
    s_add_u32 m0, s60, 67584
    s_nop 0
    buffer_load_dwordx4 v42, s[24:27], s40 offen lds
    s_add_u32 m0, s60, 68608
    s_nop 0
    buffer_load_dwordx4 v43, s[24:27], s40 offen lds
    s_add_u32 m0, s60, 69632
    s_nop 0
    buffer_load_dwordx4 v44, s[24:27], s40 offen lds
    s_add_u32 m0, s100, 86016
    s_nop 0
    buffer_load_dwordx4 v45, s[20:23], s101 offen lds
    s_add_u32 m0, s100, 87040
    s_nop 0
    buffer_load_dwordx4 v46, s[20:23], s101 offen lds
    s_waitcnt vmcnt(15)
    s_waitcnt vmcnt(38)
    s_barrier
    s_cmp_lg_u32 s98, 0
    s_cbranch_scc1 L_26
    s_lshl_b32 s62, s4, 5
    v_mov_b32 v4, s62
    v_mov_b32 v5, 1
    s_mov_b64 s[62:63], exec
    s_mov_b64 exec, 1
    buffer_atomic_add v5, v4, s[36:39], 0 offen offset:0 sc1
    s_mov_b64 exec, s[62:63]
L_26:
    s_waitcnt vmcnt(8)
    s_barrier
    s_add_u32 s62, s61, 1
    s_and_b32 s62, s62, 3
    s_add_u32 s63, s41, 0
    s_cmp_ge_u32 s63, 3
    s_cselect_b32 s46, 3, 0
    s_sub_u32 s63, s63, s46
    s_mul_i32 s40, s62, 245760
    s_mul_i32 s46, s63, 81920
    s_add_u32 s40, s40, s46
    s_mul_i32 s101, s62, 24576
    s_lshl_b32 s46, s63, 7
    s_add_u32 s101, s101, s46
    s_add_u32 m0, s60, 98304
    s_nop 0
    buffer_load_dwordx4 v40, s[24:27], s40 offen lds
    s_add_u32 m0, s60, 99328
    s_nop 0
    buffer_load_dwordx4 v41, s[24:27], s40 offen lds
    s_add_u32 m0, s60, 100352
    s_nop 0
    buffer_load_dwordx4 v42, s[24:27], s40 offen lds
    s_add_u32 m0, s60, 101376
    s_nop 0
    buffer_load_dwordx4 v43, s[24:27], s40 offen lds
    s_add_u32 m0, s60, 102400
    s_nop 0
    buffer_load_dwordx4 v44, s[24:27], s40 offen lds
    s_add_u32 m0, s100, 118784
    s_nop 0
    buffer_load_dwordx4 v45, s[20:23], s101 offen lds
    s_add_u32 m0, s100, 119808
    s_nop 0
    buffer_load_dwordx4 v46, s[20:23], s101 offen lds
    s_waitcnt vmcnt(7)
    s_barrier
    s_add_u32 s62, s61, 1
    s_and_b32 s62, s62, 3
    s_add_u32 s63, s41, 1
    s_cmp_ge_u32 s63, 3
    s_cselect_b32 s46, 3, 0
    s_sub_u32 s63, s63, s46
    s_mul_i32 s40, s62, 245760
    s_mul_i32 s46, s63, 81920
    s_add_u32 s40, s40, s46
    s_mul_i32 s101, s62, 24576
    s_lshl_b32 s46, s63, 7
    s_add_u32 s101, s101, s46
    s_add_u32 m0, s60, 0
    s_nop 0
    buffer_load_dwordx4 v40, s[24:27], s40 offen lds
    s_add_u32 m0, s60, 1024
    s_nop 0
    buffer_load_dwordx4 v41, s[24:27], s40 offen lds
    s_add_u32 m0, s60, 2048
    s_nop 0
    buffer_load_dwordx4 v42, s[24:27], s40 offen lds
    s_add_u32 m0, s60, 3072
    s_nop 0
    buffer_load_dwordx4 v43, s[24:27], s40 offen lds
    s_add_u32 m0, s60, 4096
    s_nop 0
    buffer_load_dwordx4 v44, s[24:27], s40 offen lds
    s_add_u32 m0, s100, 20480
    s_nop 0
    buffer_load_dwordx4 v45, s[20:23], s101 offen lds
    s_add_u32 m0, s100, 21504
    s_nop 0
    buffer_load_dwordx4 v46, s[20:23], s101 offen lds
    s_add_u32 s62, s61, 1
    s_and_b32 s62, s62, 3
    s_add_u32 s63, s41, 2
    s_cmp_ge_u32 s63, 3
    s_cselect_b32 s46, 3, 0
    s_sub_u32 s63, s63, s46
    s_mul_i32 s40, s62, 245760
    s_mul_i32 s46, s63, 81920
    s_add_u32 s40, s40, s46
    s_mul_i32 s101, s62, 24576
    s_lshl_b32 s46, s63, 7
    s_add_u32 s101, s101, s46
    s_add_u32 m0, s60, 131072
    s_nop 0
    buffer_load_dwordx4 v40, s[24:27], s40 offen lds
    s_add_u32 m0, s60, 132096
    s_nop 0
    buffer_load_dwordx4 v41, s[24:27], s40 offen lds
    s_add_u32 m0, s60, 133120
    s_nop 0
    buffer_load_dwordx4 v42, s[24:27], s40 offen lds
    s_add_u32 m0, s60, 134144
    s_nop 0
    buffer_load_dwordx4 v43, s[24:27], s40 offen lds
    s_add_u32 m0, s60, 135168
    s_nop 0
    buffer_load_dwordx4 v44, s[24:27], s40 offen lds
    s_add_u32 m0, s100, 151552
    s_nop 0
    buffer_load_dwordx4 v45, s[20:23], s101 offen lds
    s_add_u32 m0, s100, 152576
    s_nop 0
    buffer_load_dwordx4 v46, s[20:23], s101 offen lds
    s_waitcnt vmcnt(14)
    s_barrier
    s_add_u32 s62, s61, 2
    s_and_b32 s62, s62, 3
    s_add_u32 s63, s41, 0
    s_cmp_ge_u32 s63, 3
    s_cselect_b32 s46, 3, 0
    s_sub_u32 s63, s63, s46
    s_mul_i32 s40, s62, 245760
    s_mul_i32 s46, s63, 81920
    s_add_u32 s40, s40, s46
    s_mul_i32 s101, s62, 24576
    s_lshl_b32 s46, s63, 7
    s_add_u32 s101, s101, s46
    s_add_u32 m0, s60, 32768
    s_nop 0
    buffer_load_dwordx4 v40, s[24:27], s40 offen lds
    s_add_u32 m0, s60, 33792
    s_nop 0
    buffer_load_dwordx4 v41, s[24:27], s40 offen lds
    s_add_u32 m0, s60, 34816
    s_nop 0
    buffer_load_dwordx4 v42, s[24:27], s40 offen lds
    s_add_u32 m0, s60, 35840
    s_nop 0
    buffer_load_dwordx4 v43, s[24:27], s40 offen lds
    s_add_u32 m0, s60, 36864
    s_nop 0
    buffer_load_dwordx4 v44, s[24:27], s40 offen lds
    s_add_u32 m0, s100, 53248
    s_nop 0
    buffer_load_dwordx4 v45, s[20:23], s101 offen lds
    s_add_u32 m0, s100, 54272
    s_nop 0
    buffer_load_dwordx4 v46, s[20:23], s101 offen lds
    s_waitcnt vmcnt(14)
    s_barrier
    s_add_u32 s62, s61, 2
    s_and_b32 s62, s62, 3
    s_add_u32 s63, s41, 1
    s_cmp_ge_u32 s63, 3
    s_cselect_b32 s46, 3, 0
    s_sub_u32 s63, s63, s46
    s_mul_i32 s40, s62, 245760
    s_mul_i32 s46, s63, 81920
    s_add_u32 s40, s40, s46
    s_mul_i32 s101, s62, 24576
    s_lshl_b32 s46, s63, 7
    s_add_u32 s101, s101, s46
    s_add_u32 m0, s60, 65536
    s_nop 0
    buffer_load_dwordx4 v40, s[24:27], s40 offen lds
    s_add_u32 m0, s60, 66560
    s_nop 0
    buffer_load_dwordx4 v41, s[24:27], s40 offen lds
    s_add_u32 m0, s60, 67584
    s_nop 0
    buffer_load_dwordx4 v42, s[24:27], s40 offen lds
    s_add_u32 m0, s60, 68608
    s_nop 0
    buffer_load_dwordx4 v43, s[24:27], s40 offen lds
    s_add_u32 m0, s60, 69632
    s_nop 0
    buffer_load_dwordx4 v44, s[24:27], s40 offen lds
    s_add_u32 m0, s100, 86016
    s_nop 0
    buffer_load_dwordx4 v45, s[20:23], s101 offen lds
    s_add_u32 m0, s100, 87040
    s_nop 0
    buffer_load_dwordx4 v46, s[20:23], s101 offen lds
    s_waitcnt vmcnt(14)
    s_barrier
    s_cmp_lg_u32 s98, 0
    s_cbranch_scc1 L_27
    s_lshl_b32 s62, s4, 5
    v_mov_b32 v16, s62
    buffer_load_dword v15, v16, s[36:39], 0 offen offset:0 sc1
L_27:
    s_add_u32 s62, s61, 2
    s_and_b32 s62, s62, 3
    s_add_u32 s63, s41, 2
    s_cmp_ge_u32 s63, 3
    s_cselect_b32 s46, 3, 0
    s_sub_u32 s63, s63, s46
    s_mul_i32 s40, s62, 245760
    s_mul_i32 s46, s63, 81920
    s_add_u32 s40, s40, s46
    s_mul_i32 s101, s62, 24576
    s_lshl_b32 s46, s63, 7
    s_add_u32 s101, s101, s46
    s_add_u32 m0, s60, 98304
    s_nop 0
    buffer_load_dwordx4 v40, s[24:27], s40 offen lds
    s_add_u32 m0, s60, 99328
    s_nop 0
    buffer_load_dwordx4 v41, s[24:27], s40 offen lds
    s_add_u32 m0, s60, 100352
    s_nop 0
    buffer_load_dwordx4 v42, s[24:27], s40 offen lds
    s_add_u32 m0, s60, 101376
    s_nop 0
    buffer_load_dwordx4 v43, s[24:27], s40 offen lds
    s_add_u32 m0, s60, 102400
    s_nop 0
    buffer_load_dwordx4 v44, s[24:27], s40 offen lds
    s_add_u32 m0, s100, 118784
    s_nop 0
    buffer_load_dwordx4 v45, s[20:23], s101 offen lds
    s_add_u32 m0, s100, 119808
    s_nop 0
    buffer_load_dwordx4 v46, s[20:23], s101 offen lds
    s_waitcnt vmcnt(14)
    s_barrier
    s_cmp_lg_u32 s98, 0
    s_cbranch_scc1 L_28
    s_waitcnt vmcnt(7)
    s_mov_b32 s48, 0
L_29:
    v_readfirstlane_b32 s62, v15
    s_cmp_ge_u32 s62, 32
    s_cbranch_scc1 L_30
    s_add_u32 s48, s48, 1
    s_cmp_gt_u32 s48, 200000
    s_cbranch_scc1 L_30
    s_sleep 2
    buffer_load_dword v15, v16, s[36:39], 0 offen offset:0 sc1
    s_waitcnt vmcnt(0)
    s_branch L_29
L_30:
L_28:
    s_add_u32 s62, s61, 3
    s_and_b32 s62, s62, 3
    s_add_u32 s63, s41, 0
    s_cmp_ge_u32 s63, 3
    s_cselect_b32 s46, 3, 0
    s_sub_u32 s63, s63, s46
    s_mul_i32 s40, s62, 245760
    s_mul_i32 s46, s63, 81920
    s_add_u32 s40, s40, s46
    s_mul_i32 s101, s62, 24576
    s_lshl_b32 s46, s63, 7
    s_add_u32 s101, s101, s46
    s_add_u32 m0, s60, 0
    s_nop 0
    buffer_load_dwordx4 v40, s[24:27], s40 offen lds
    s_add_u32 m0, s60, 1024
    s_nop 0
    buffer_load_dwordx4 v41, s[24:27], s40 offen lds
    s_add_u32 m0, s60, 2048
    s_nop 0
    buffer_load_dwordx4 v42, s[24:27], s40 offen lds
    s_add_u32 m0, s60, 3072
    s_nop 0
    buffer_load_dwordx4 v43, s[24:27], s40 offen lds
    s_add_u32 m0, s60, 4096
    s_nop 0
    buffer_load_dwordx4 v44, s[24:27], s40 offen lds
    s_add_u32 m0, s100, 20480
    s_nop 0
    buffer_load_dwordx4 v45, s[20:23], s101 offen lds
    s_add_u32 m0, s100, 21504
    s_nop 0
    buffer_load_dwordx4 v46, s[20:23], s101 offen lds
    s_waitcnt vmcnt(14)
    s_barrier
    s_add_u32 s62, s61, s98
    s_and_b32 s62, s62, 3
    s_lshl_b32 s62, s62, 7
    s_add_u32 s56, s62, s43
    v_lshlrev_b32 v18, 2, v1
    buffer_load_dword v17, v18, s[28:31], s56 offen sc1
    s_add_u32 s62, s61, 3
    s_and_b32 s62, s62, 3
    s_add_u32 s63, s41, 1
    s_cmp_ge_u32 s63, 3
    s_cselect_b32 s46, 3, 0
    s_sub_u32 s63, s63, s46
    s_mul_i32 s40, s62, 245760
    s_mul_i32 s46, s63, 81920
    s_add_u32 s40, s40, s46
    s_mul_i32 s101, s62, 24576
    s_lshl_b32 s46, s63, 7
    s_add_u32 s101, s101, s46
    s_add_u32 m0, s60, 131072
    s_nop 0
    buffer_load_dwordx4 v40, s[24:27], s40 offen lds
    s_add_u32 m0, s60, 132096
    s_nop 0
    buffer_load_dwordx4 v41, s[24:27], s40 offen lds
    s_add_u32 m0, s60, 133120
    s_nop 0
    buffer_load_dwordx4 v42, s[24:27], s40 offen lds
    s_add_u32 m0, s60, 134144
    s_nop 0
    buffer_load_dwordx4 v43, s[24:27], s40 offen lds
    s_add_u32 m0, s60, 135168
    s_nop 0
    buffer_load_dwordx4 v44, s[24:27], s40 offen lds
    s_add_u32 m0, s100, 151552
    s_nop 0
    buffer_load_dwordx4 v45, s[20:23], s101 offen lds
    s_add_u32 m0, s100, 152576
    s_nop 0
    buffer_load_dwordx4 v46, s[20:23], s101 offen lds
    s_waitcnt vmcnt(15)
    s_barrier
    s_add_u32 s62, s61, 3
    s_and_b32 s62, s62, 3
    s_add_u32 s63, s41, 2
    s_cmp_ge_u32 s63, 3
    s_cselect_b32 s46, 3, 0
    s_sub_u32 s63, s63, s46
    s_mul_i32 s40, s62, 245760
    s_mul_i32 s46, s63, 81920
    s_add_u32 s40, s40, s46
    s_mul_i32 s101, s62, 24576
    s_lshl_b32 s46, s63, 7
    s_add_u32 s101, s101, s46
    s_add_u32 m0, s60, 32768
    s_nop 0
    buffer_load_dwordx4 v40, s[24:27], s40 offen lds
    s_add_u32 m0, s60, 33792
    s_nop 0
    buffer_load_dwordx4 v41, s[24:27], s40 offen lds
    s_add_u32 m0, s60, 34816
    s_nop 0
    buffer_load_dwordx4 v42, s[24:27], s40 offen lds
    s_add_u32 m0, s60, 35840
    s_nop 0
    buffer_load_dwordx4 v43, s[24:27], s40 offen lds
    s_add_u32 m0, s60, 36864
    s_nop 0
    buffer_load_dwordx4 v44, s[24:27], s40 offen lds
    s_add_u32 m0, s100, 53248
    s_nop 0
    buffer_load_dwordx4 v45, s[20:23], s101 offen lds
    s_add_u32 m0, s100, 54272
    s_nop 0
    buffer_load_dwordx4 v46, s[20:23], s101 offen lds
    s_waitcnt vmcnt(15)
    s_barrier
    s_waitcnt vmcnt(14)
    s_mov_b32 s48, 0
    s_mov_b64 s[62:63], exec
    s_mov_b64 exec, 0xf
L_31:
    v_cmp_ne_u32 vcc, 1, v17
    s_cbranch_vccz L_32
    s_add_u32 s48, s48, 1
    s_cmp_gt_u32 s48, 200000
    s_cbranch_scc1 L_32
    buffer_load_dword v17, v18, s[28:31], s56 offen sc1
    s_waitcnt vmcnt(0)
    s_branch L_31
L_32:
    s_mov_b64 exec, s[62:63]
    s_lshl_b32 s62, s4, 5
    s_lshl_b32 s63, s5, 2
    s_add_u32 s47, s62, s63
    s_add_u32 s62, s61, s98
    s_and_b32 s62, s62, 3
    s_add_u32 s62, s62, s47
    s_lshl_b32 s62, s62, 13
    buffer_load_dwordx4 v[48:51], v10, s[28:31], s62 offen offset:0 sc1
    buffer_load_dwordx4 v[52:55], v10, s[28:31], s62 offen offset:1024 sc1
    buffer_load_dwordx4 v[56:59], v10, s[28:31], s62 offen offset:2048 sc1
    buffer_load_dwordx4 v[60:63], v10, s[28:31], s62 offen offset:3072 sc1
    s_add_u32 s62, s62, 4096
    buffer_load_dwordx4 v[64:67], v10, s[28:31], s62 offen offset:0 sc1
    buffer_load_dwordx4 v[68:71], v10, s[28:31], s62 offen offset:1024 sc1
    buffer_load_dwordx4 v[72:75], v10, s[28:31], s62 offen offset:2048 sc1
    buffer_load_dwordx4 v[76:79], v10, s[28:31], s62 offen offset:3072 sc1
    s_waitcnt vmcnt(15)
    s_barrier
    s_waitcnt vmcnt(8)
    s_barrier
    s_waitcnt vmcnt(0)
    s_lshl_b32 s62, s98, 13
    s_add_u32 s62, s62, 65536
    v_add_u32 v16, s62, v10
    ds_write_b128 v16, v[48:51] offset:0
    ds_write_b128 v16, v[52:55] offset:1024
    ds_write_b128 v16, v[56:59] offset:2048
    ds_write_b128 v16, v[60:63] offset:3072
    ds_write_b128 v16, v[64:67] offset:4096
    ds_write_b128 v16, v[68:71] offset:5120
    ds_write_b128 v16, v[72:75] offset:6144
    ds_write_b128 v16, v[76:79] offset:7168
    s_waitcnt lgkmcnt(0)
    s_barrier
    s_barrier
    s_cmp_lg_u32 s3, 4
    s_cbranch_scc1 L_33
    s_mov_b32 s56, 4
    v_mul_u32_u24 v22, 1280, v12
    v_lshl_add_u32 v22, v13, 3, v22
    s_lshl_b32 s62, s56, 9
    s_add_u32 s47, s51, s62
    s_mov_b32 s48, 0
L_34:
    s_add_u32 s62, s47, 0
    buffer_load_dwordx2 v[48:49], v11, s[28:31], s62 offen sc1
    s_add_u32 s62, s47, 20480
    buffer_load_dwordx2 v[50:51], v11, s[28:31], s62 offen sc1
    s_add_u32 s62, s47, 40960
    buffer_load_dwordx2 v[52:53], v11, s[28:31], s62 offen sc1
    s_add_u32 s62, s47, 61440
    buffer_load_dwordx2 v[54:55], v11, s[28:31], s62 offen sc1
    s_add_u32 s62, s47, 81920
    buffer_load_dwordx2 v[56:57], v11, s[28:31], s62 offen sc1
    s_add_u32 s62, s47, 102400
    buffer_load_dwordx2 v[58:59], v11, s[28:31], s62 offen sc1
    s_add_u32 s62, s47, 122880
    buffer_load_dwordx2 v[60:61], v11, s[28:31], s62 offen sc1
    s_add_u32 s62, s47, 143360
    buffer_load_dwordx2 v[62:63], v11, s[28:31], s62 offen sc1
    s_waitcnt vmcnt(0)
    v_max3_u32 v14, v48, v49, v50
    v_max3_u32 v14, v14, v51, v52
    v_max3_u32 v14, v14, v53, v54
    v_max3_u32 v14, v14, v55, v56
    v_max3_u32 v14, v14, v57, v58
    v_max3_u32 v14, v14, v59, v60
    v_max3_u32 v14, v14, v61, v62
    v_max_u32 v14, v14, v63
    v_cmp_eq_u32 vcc, -1, v14
    s_cbranch_vccz L_35
    s_add_u32 s48, s48, 1
    s_cmp_gt_u32 s48, 200000
    s_cbranch_scc0 L_34
L_35:
    v_lshlrev_b32 v16, 16, v48
    v_and_b32 v17, 0xffff0000, v48
    v_lshlrev_b32 v18, 16, v49
    v_and_b32 v19, 0xffff0000, v49
    v_lshlrev_b32 v20, 16, v50
    v_and_b32 v21, 0xffff0000, v50
    v_add_f32 v16, v16, v20
    v_add_f32 v17, v17, v21
    v_lshlrev_b32 v20, 16, v51
    v_and_b32 v21, 0xffff0000, v51
    v_add_f32 v18, v18, v20
    v_add_f32 v19, v19, v21
    v_lshlrev_b32 v20, 16, v52
    v_and_b32 v21, 0xffff0000, v52
    v_add_f32 v16, v16, v20
    v_add_f32 v17, v17, v21
    v_lshlrev_b32 v20, 16, v53
    v_and_b32 v21, 0xffff0000, v53
    v_add_f32 v18, v18, v20
    v_add_f32 v19, v19, v21
    v_lshlrev_b32 v20, 16, v54
    v_and_b32 v21, 0xffff0000, v54
    v_add_f32 v16, v16, v20
    v_add_f32 v17, v17, v21
    v_lshlrev_b32 v20, 16, v55
    v_and_b32 v21, 0xffff0000, v55
    v_add_f32 v18, v18, v20
    v_add_f32 v19, v19, v21
    v_lshlrev_b32 v20, 16, v56
    v_and_b32 v21, 0xffff0000, v56
    v_add_f32 v16, v16, v20
    v_add_f32 v17, v17, v21
    v_lshlrev_b32 v20, 16, v57
    v_and_b32 v21, 0xffff0000, v57
    v_add_f32 v18, v18, v20
    v_add_f32 v19, v19, v21
    v_lshlrev_b32 v20, 16, v58
    v_and_b32 v21, 0xffff0000, v58
    v_add_f32 v16, v16, v20
    v_add_f32 v17, v17, v21
    v_lshlrev_b32 v20, 16, v59
    v_and_b32 v21, 0xffff0000, v59
    v_add_f32 v18, v18, v20
    v_add_f32 v19, v19, v21
    v_lshlrev_b32 v20, 16, v60
    v_and_b32 v21, 0xffff0000, v60
    v_add_f32 v16, v16, v20
    v_add_f32 v17, v17, v21
    v_lshlrev_b32 v20, 16, v61
    v_and_b32 v21, 0xffff0000, v61
    v_add_f32 v18, v18, v20
    v_add_f32 v19, v19, v21
    v_lshlrev_b32 v20, 16, v62
    v_and_b32 v21, 0xffff0000, v62
    v_add_f32 v16, v16, v20
    v_add_f32 v17, v17, v21
    v_lshlrev_b32 v20, 16, v63
    v_and_b32 v21, 0xffff0000, v63
    v_add_f32 v18, v18, v20
    v_add_f32 v19, v19, v21
    v_cvt_pk_bf16_f32 v20, v16, v17
    v_cvt_pk_bf16_f32 v21, v18, v19
    s_lshl_b32 s62, s56, 5
    s_add_u32 s62, s62, s52
    buffer_store_dwordx2 v[20:21], v22, s[32:35], s62 offen
L_33:
    s_endpgm
L_var3:
    v_lshlrev_b32 v3, 4, v9
    v_add_u32 v4, 0, v1
    v_mul_u32_u24 v5, 2731, v4
    v_lshrrev_b32 v5, 16, v5
    v_mul_u32_u24 v6, 24, v5
    v_sub_u32 v6, v4, v6
    v_bfe_u32 v7, v5, 1, 1
    v_lshlrev_b32 v7, 1, v7
    v_xor_b32 v6, v6, v7
    v_add_u32 v5, v5, v3
    v_mul_u32_u24 v5, 12288, v5
    v_lshl_add_u32 v24, v6, 4, v5
    v_add_u32 v27, 98304, v24
    v_xor_b32 v27, 64, v27
    v_add_u32 v4, 64, v1
    v_mul_u32_u24 v5, 2731, v4
    v_lshrrev_b32 v5, 16, v5
    v_mul_u32_u24 v6, 24, v5
    v_sub_u32 v6, v4, v6
    v_bfe_u32 v7, v5, 1, 1
    v_lshlrev_b32 v7, 1, v7
    v_xor_b32 v6, v6, v7
    v_add_u32 v5, v5, v3
    v_mul_u32_u24 v5, 12288, v5
    v_lshl_add_u32 v25, v6, 4, v5
    v_add_u32 v28, 98304, v25
    v_xor_b32 v28, 64, v28
    v_add_u32 v4, 128, v1
    v_mul_u32_u24 v5, 2731, v4
    v_lshrrev_b32 v5, 16, v5
    v_mul_u32_u24 v6, 24, v5
    v_sub_u32 v6, v4, v6
    v_bfe_u32 v7, v5, 1, 1
    v_lshlrev_b32 v7, 1, v7
    v_xor_b32 v6, v6, v7
    v_add_u32 v5, v5, v3
    v_mul_u32_u24 v5, 12288, v5
    v_lshl_add_u32 v26, v6, 4, v5
    v_add_u32 v29, 98304, v26
    v_xor_b32 v29, 64, v29
    v_lshrrev_b32 v5, 3, v1
    v_and_b32 v6, 7, v1
    v_lshrrev_b32 v7, 1, v5
    v_xor_b32 v6, v6, v7
    v_add_u32 v5, v5, v3
    v_mul_u32_u24 v7, 1280, v5
    v_lshl_add_u32 v30, v6, 4, v7
    v_add_u32 v31, 10240, v30
    v_xor_b32 v31, 64, v31
    v_mul_u32_u24 v7, 384, v5
    v_lshl_add_u32 v45, v6, 4, v7
    v_add_u32 v46, 3072, v45
    v_xor_b32 v46, 64, v46
    s_mul_i32 s59, s98, 6144
    s_mul_i32 s60, s98, 5120
    s_mov_b32 s56, s4
    s_mul_i32 s62, s4, 81920
    s_mul_i32 s63, s7, 384
    s_waitcnt lgkmcnt(0)
    s_add_u32 s8, s40, s62
    s_addc_u32 s9, s41, 0
    s_mov_b32 s10, 81920
    s_mov_b32 s11, 0x00020000
    s_add_u32 s12, s46, s63
    s_addc_u32 s13, s47, 0
    s_mov_b32 s14, 7852416
    s_mov_b32 s15, 0x00020000
    s_mul_i32 s57, s56, 786432
    s_lshl_b32 s58, s56, 7
    s_add_u32 m0, s59, 0
    s_nop 0
    buffer_load_dwordx4 v24, s[12:15], s57 offen lds
    s_add_u32 m0, s59, 1024
    s_nop 0
    buffer_load_dwordx4 v25, s[12:15], s57 offen lds
    s_add_u32 m0, s59, 2048
    s_nop 0
    buffer_load_dwordx4 v26, s[12:15], s57 offen lds
    s_add_u32 m0, s59, 3072
    s_nop 0
    buffer_load_dwordx4 v27, s[12:15], s57 offen lds
    s_add_u32 m0, s59, 4096
    s_nop 0
    buffer_load_dwordx4 v28, s[12:15], s57 offen lds
    s_add_u32 m0, s59, 5120
    s_nop 0
    buffer_load_dwordx4 v29, s[12:15], s57 offen lds
    s_add_u32 m0, s100, 24576
    s_nop 0
    buffer_load_dwordx4 v30, s[8:11], s58 offen lds
    s_add_u32 m0, s100, 25600
    s_nop 0
    buffer_load_dwordx4 v31, s[8:11], s58 offen lds
    s_add_u32 s56, s56, 1
    s_cmp_ge_u32 s56, 10
    s_cselect_b32 s56, 0, s56
    v_and_b32 v12, 15, v1
    v_lshrrev_b32 v13, 4, v1
    v_lshlrev_b32 v10, 4, v1
    v_lshlrev_b32 v11, 3, v1
    s_mul_i32 s62, s6, 160
    s_mul_i32 s63, s98, 40
    s_add_u32 s62, s62, s63
    v_min_u32 v4, 39, v1
    v_add_u32 v4, s62, v4
    v_lshlrev_b32 v19, 7, v4
    s_mul_i32 s62, s4, 48
    s_mul_i32 s63, s98, 12
    s_add_u32 s62, s62, s63
    v_min_u32 v4, 11, v1
    v_add_u32 v4, s62, v4
    v_mul_u32_u24 v5, 21846, v4
    v_lshrrev_b32 v5, 16, v5
    v_mul_u32_u24 v6, 3, v5
    v_sub_u32 v6, v4, v6
    v_add_u32 v5, 512, v5
    v_mul_u32_u24 v5, 12288, v5
    v_lshl_add_u32 v20, v6, 7, v5
    buffer_load_dword v80, v19, s[8:11], 0 offen
    buffer_load_dword v81, v20, s[12:15], 0 offen
    s_lshl_b32 s62, s4, 5
    s_add_u32 s63, s62, s7
    s_mul_i32 s63, s63, 24576
    s_add_u32 s16, s42, s63
    s_addc_u32 s17, s43, 0
    s_mov_b32 s18, 24576
    s_mov_b32 s19, 0x00020000
    s_lshl_b32 s63, s5, 2
    s_add_u32 s63, s63, s62
    s_mul_i32 s63, s63, 24576
    s_add_u32 s20, s44, s63
    s_addc_u32 s21, s45, 0
    s_mov_b32 s22, 98304
    s_mov_b32 s23, 0x00020000
    s_mul_i32 s62, s5, 983040
    s_mul_i32 s63, s6, 320
    s_add_u32 s62, s62, s63
    s_add_u32 s24, s48, s62
    s_addc_u32 s25, s49, 0
    s_mov_b32 s26, 982080
    s_mov_b32 s27, 0x00020000
    s_mov_b32 s32, s50
    s_mov_b32 s33, s51
    s_mov_b32 s34, 655360
    s_mov_b32 s35, 0x00020000
    s_mov_b32 s36, s52
    s_mov_b32 s37, s53
    s_mov_b32 s38, 256
    s_mov_b32 s39, 0x00020000
    s_mov_b32 s28, s54
    s_mov_b32 s29, s55
    s_mov_b32 s30, 268435456
    s_mov_b32 s31, 0x00020000
    s_lshl_b32 s62, s4, 5
    s_add_u32 s62, s62, s7
    s_lshl_b32 s45, s62, 13
    s_lshl_b32 s63, s62, 7
    s_add_u32 s53, s63, 8388608
    s_lshl_b32 s62, s4, 5
    s_lshl_b32 s63, s5, 2
    s_add_u32 s63, s63, s62
    s_lshl_b32 s63, s63, 7
    s_add_u32 s43, s63, 8388608
    s_lshl_b32 s62, s4, 2
    s_add_u32 s62, s62, s6
    s_lshl_b32 s63, s62, 3
    s_add_u32 s63, s63, s5
    s_mul_i32 s63, s63, 20480
    s_add_u32 s63, s63, 2097152
    s_mul_i32 s50, s98, 5120
    s_add_u32 s50, s50, s63
    s_mul_i32 s62, s62, 163840
    s_mul_i32 s63, s5, 2560
    s_add_u32 s62, s62, s63
    s_add_u32 s51, s62, 2097152
    s_lshr_b32 s62, s5, 2
    s_lshl_b32 s62, s62, 1
    s_and_b32 s63, s5, 1
    s_add_u32 s62, s62, s63
    s_lshl_b32 s62, s62, 4
    s_lshl_b32 s63, s4, 6
    s_add_u32 s62, s62, s63
    s_mul_i32 s62, s62, 1280
    s_mul_i32 s63, s6, 320
    s_add_u32 s62, s62, s63
    s_lshr_b32 s63, s5, 1
    s_and_b32 s63, s63, 1
    s_mul_i32 s63, s63, 160
    s_add_u32 s52, s62, s63
    s_mov_b32 s49, 0xfffffffe
    s_lshl_b32 s62, s4, 5
    s_add_u32 s62, s62, s6
    s_lshl_b32 s62, s62, 7
    s_add_u32 s42, s62, 8388608
    s_lshr_b32 s62, s4, 1
    s_add_u32 s62, s62, s6
    s_and_b32 s61, s62, 3
    s_and_b32 s62, s4, 1
    s_lshl_b32 s41, s62, 1
    v_add_u32 v4, 0, v1
    v_mul_u32_u24 v5, 2731, v4
    v_lshrrev_b32 v5, 16, v5
    v_mul_u32_u24 v6, 24, v5
    v_sub_u32 v6, v4, v6
    v_bfe_u32 v7, v5, 1, 3
    v_xor_b32 v6, v6, v7
    v_add_u32 v5, v5, v3
    v_mul_u32_u24 v5, 384, v5
    v_lshl_add_u32 v32, v6, 4, v5
    v_add_u32 v4, 64, v1
    v_mul_u32_u24 v5, 2731, v4
    v_lshrrev_b32 v5, 16, v5
    v_mul_u32_u24 v6, 24, v5
    v_sub_u32 v6, v4, v6
    v_bfe_u32 v7, v5, 1, 3
    v_xor_b32 v6, v6, v7
    v_add_u32 v5, v5, v3
    v_mul_u32_u24 v5, 384, v5
    v_lshl_add_u32 v33, v6, 4, v5
    v_add_u32 v4, 128, v1
    v_mul_u32_u24 v5, 2731, v4
    v_lshrrev_b32 v5, 16, v5
    v_mul_u32_u24 v6, 24, v5
    v_sub_u32 v6, v4, v6
    v_bfe_u32 v7, v5, 1, 3
    v_xor_b32 v6, v6, v7
    v_add_u32 v5, v5, v3
    v_mul_u32_u24 v5, 384, v5
    v_lshl_add_u32 v34, v6, 4, v5
    v_add_u32 v4, 192, v1
    v_mul_u32_u24 v5, 2731, v4
    v_lshrrev_b32 v5, 16, v5
    v_mul_u32_u24 v6, 24, v5
    v_sub_u32 v6, v4, v6
    v_bfe_u32 v7, v5, 1, 3
    v_xor_b32 v6, v6, v7
    v_add_u32 v5, v5, v3
    v_mul_u32_u24 v5, 384, v5
    v_lshl_add_u32 v35, v6, 4, v5
    v_add_u32 v4, 256, v1
    v_mul_u32_u24 v5, 2731, v4
    v_lshrrev_b32 v5, 16, v5
    v_mul_u32_u24 v6, 24, v5
    v_sub_u32 v6, v4, v6
    v_bfe_u32 v7, v5, 1, 3
    v_xor_b32 v6, v6, v7
    v_add_u32 v5, v5, v3
    v_mul_u32_u24 v5, 384, v5
    v_lshl_add_u32 v36, v6, 4, v5
    v_add_u32 v4, 320, v1
    v_mul_u32_u24 v5, 2731, v4
    v_lshrrev_b32 v5, 16, v5
    v_mul_u32_u24 v6, 24, v5
    v_sub_u32 v6, v4, v6
    v_bfe_u32 v7, v5, 1, 3
    v_xor_b32 v6, v6, v7
    v_add_u32 v5, v5, v3
    v_mul_u32_u24 v5, 384, v5
    v_lshl_add_u32 v37, v6, 4, v5
    v_add_u32 v4, 0, v1
    v_mul_u32_u24 v5, 3277, v4
    v_lshrrev_b32 v5, 16, v5
    v_mul_u32_u24 v6, 20, v5
    v_sub_u32 v6, v4, v6
    v_bfe_u32 v7, v5, 3, 1
    v_lshlrev_b32 v7, 1, v7
    v_xor_b32 v6, v6, v7
    v_add_u32 v5, v5, v3
    v_mul_u32_u24 v5, 1280, v5
    v_lshl_add_u32 v40, v6, 4, v5
    v_add_u32 v4, 64, v1
    v_mul_u32_u24 v5, 3277, v4
    v_lshrrev_b32 v5, 16, v5
    v_mul_u32_u24 v6, 20, v5
    v_sub_u32 v6, v4, v6
    v_bfe_u32 v7, v5, 3, 1
    v_lshlrev_b32 v7, 1, v7
    v_xor_b32 v6, v6, v7
    v_add_u32 v5, v5, v3
    v_mul_u32_u24 v5, 1280, v5
    v_lshl_add_u32 v41, v6, 4, v5
    v_add_u32 v4, 128, v1
    v_mul_u32_u24 v5, 3277, v4
    v_lshrrev_b32 v5, 16, v5
    v_mul_u32_u24 v6, 20, v5
    v_sub_u32 v6, v4, v6
    v_bfe_u32 v7, v5, 3, 1
    v_lshlrev_b32 v7, 1, v7
    v_xor_b32 v6, v6, v7
    v_add_u32 v5, v5, v3
    v_mul_u32_u24 v5, 1280, v5
    v_lshl_add_u32 v42, v6, 4, v5
    v_add_u32 v4, 192, v1
    v_mul_u32_u24 v5, 3277, v4
    v_lshrrev_b32 v5, 16, v5
    v_mul_u32_u24 v6, 20, v5
    v_sub_u32 v6, v4, v6
    v_bfe_u32 v7, v5, 3, 1
    v_lshlrev_b32 v7, 1, v7
    v_xor_b32 v6, v6, v7
    v_add_u32 v5, v5, v3
    v_mul_u32_u24 v5, 1280, v5
    v_lshl_add_u32 v43, v6, 4, v5
    v_add_u32 v4, 256, v1
    v_mul_u32_u24 v5, 3277, v4
    v_lshrrev_b32 v5, 16, v5
    v_mul_u32_u24 v6, 20, v5
    v_sub_u32 v6, v4, v6
    v_bfe_u32 v7, v5, 3, 1
    v_lshlrev_b32 v7, 1, v7
    v_xor_b32 v6, v6, v7
    v_add_u32 v5, v5, v3
    v_mul_u32_u24 v5, 1280, v5
    v_lshl_add_u32 v44, v6, 4, v5
    v_mov_b32 v16, 0
    v_mov_b32 v22, 0
    v_mov_b32 v84, -1
    v_mov_b32 v85, -1
    v_mov_b32 v86, -1
    v_mov_b32 v87, -1
    s_mul_i32 s57, s56, 786432
    s_lshl_b32 s58, s56, 7
    s_add_u32 m0, s59, 32768
    s_nop 0
    buffer_load_dwordx4 v24, s[12:15], s57 offen lds
    s_add_u32 m0, s59, 33792
    s_nop 0
    buffer_load_dwordx4 v25, s[12:15], s57 offen lds
    s_add_u32 m0, s59, 34816
    s_nop 0
    buffer_load_dwordx4 v26, s[12:15], s57 offen lds
    s_add_u32 m0, s59, 35840
    s_nop 0
    buffer_load_dwordx4 v27, s[12:15], s57 offen lds
    s_add_u32 m0, s59, 36864
    s_nop 0
    buffer_load_dwordx4 v28, s[12:15], s57 offen lds
    s_add_u32 m0, s59, 37888
    s_nop 0
    buffer_load_dwordx4 v29, s[12:15], s57 offen lds
    s_add_u32 m0, s100, 57344
    s_nop 0
    buffer_load_dwordx4 v30, s[8:11], s58 offen lds
    s_add_u32 m0, s100, 58368
    s_nop 0
    buffer_load_dwordx4 v31, s[8:11], s58 offen lds
    s_add_u32 s56, s56, 1
    s_cmp_ge_u32 s56, 10
    s_cselect_b32 s56, 0, s56
    s_waitcnt vmcnt(10)
    s_barrier
    s_mul_i32 s57, s56, 786432
    s_lshl_b32 s58, s56, 7
    s_add_u32 m0, s59, 65536
    s_nop 0
    buffer_load_dwordx4 v24, s[12:15], s57 offen lds
    s_add_u32 m0, s59, 66560
    s_nop 0
    buffer_load_dwordx4 v25, s[12:15], s57 offen lds
    s_add_u32 m0, s59, 67584
    s_nop 0
    buffer_load_dwordx4 v26, s[12:15], s57 offen lds
    s_add_u32 m0, s59, 68608
    s_nop 0
    buffer_load_dwordx4 v27, s[12:15], s57 offen lds
    s_add_u32 m0, s59, 69632
    s_nop 0
    buffer_load_dwordx4 v28, s[12:15], s57 offen lds
    s_add_u32 m0, s59, 70656
    s_nop 0
    buffer_load_dwordx4 v29, s[12:15], s57 offen lds
    s_add_u32 m0, s100, 90112
    s_nop 0
    buffer_load_dwordx4 v30, s[8:11], s58 offen lds
    s_add_u32 m0, s100, 91136
    s_nop 0
    buffer_load_dwordx4 v31, s[8:11], s58 offen lds
    s_add_u32 s56, s56, 1
    s_cmp_ge_u32 s56, 10
    s_cselect_b32 s56, 0, s56
    s_waitcnt vmcnt(8)
    s_barrier
    s_mul_i32 s57, s56, 786432
    s_lshl_b32 s58, s56, 7
    s_add_u32 m0, s59, 0
    s_nop 0
    buffer_load_dwordx4 v24, s[12:15], s57 offen lds
    s_add_u32 m0, s59, 1024
    s_nop 0
    buffer_load_dwordx4 v25, s[12:15], s57 offen lds
    s_add_u32 m0, s59, 2048
    s_nop 0
    buffer_load_dwordx4 v26, s[12:15], s57 offen lds
    s_add_u32 m0, s59, 3072
    s_nop 0
    buffer_load_dwordx4 v27, s[12:15], s57 offen lds
    s_add_u32 m0, s59, 4096
    s_nop 0
    buffer_load_dwordx4 v28, s[12:15], s57 offen lds
    s_add_u32 m0, s59, 5120
    s_nop 0
    buffer_load_dwordx4 v29, s[12:15], s57 offen lds
    s_add_u32 m0, s100, 24576
    s_nop 0
    buffer_load_dwordx4 v30, s[8:11], s58 offen lds
    s_add_u32 m0, s100, 25600
    s_nop 0
    buffer_load_dwordx4 v31, s[8:11], s58 offen lds
    s_add_u32 s56, s56, 1
    s_cmp_ge_u32 s56, 10
    s_cselect_b32 s56, 0, s56
    s_cmp_lg_u32 s98, 0
    s_cbranch_scc1 L_36
    v_lshlrev_b32 v4, 2, v1
    v_mov_b32 v5, 0
    s_mov_b64 s[62:63], exec
    s_mov_b64 exec, 0xff
    buffer_store_dword v5, v4, s[28:31], s53 offen sc1
    s_mov_b64 exec, s[62:63]
L_36:
    s_add_u32 s63, s50, 0
    buffer_store_dwordx4 v[84:87], v10, s[28:31], s63 offen sc1
    s_waitcnt vmcnt(8)
    s_barrier
    s_mul_i32 s57, s56, 786432
    s_lshl_b32 s58, s56, 7
    s_add_u32 m0, s59, 32768
    s_nop 0
    buffer_load_dwordx4 v24, s[12:15], s57 offen lds
    s_add_u32 m0, s59, 33792
    s_nop 0
    buffer_load_dwordx4 v25, s[12:15], s57 offen lds
    s_add_u32 m0, s59, 34816
    s_nop 0
    buffer_load_dwordx4 v26, s[12:15], s57 offen lds
    s_add_u32 m0, s59, 35840
    s_nop 0
    buffer_load_dwordx4 v27, s[12:15], s57 offen lds
    s_add_u32 m0, s59, 36864
    s_nop 0
    buffer_load_dwordx4 v28, s[12:15], s57 offen lds
    s_add_u32 m0, s59, 37888
    s_nop 0
    buffer_load_dwordx4 v29, s[12:15], s57 offen lds
    s_add_u32 m0, s100, 57344
    s_nop 0
    buffer_load_dwordx4 v30, s[8:11], s58 offen lds
    s_add_u32 m0, s100, 58368
    s_nop 0
    buffer_load_dwordx4 v31, s[8:11], s58 offen lds
    s_add_u32 s56, s56, 1
    s_cmp_ge_u32 s56, 10
    s_cselect_b32 s56, 0, s56
    s_add_u32 s63, s50, 1024
    buffer_store_dwordx4 v[84:87], v10, s[28:31], s63 offen sc1
    s_waitcnt vmcnt(8)
    s_barrier
    s_mul_i32 s57, s56, 786432
    s_lshl_b32 s58, s56, 7
    s_add_u32 m0, s59, 65536
    s_nop 0
    buffer_load_dwordx4 v24, s[12:15], s57 offen lds
    s_add_u32 m0, s59, 66560
    s_nop 0
    buffer_load_dwordx4 v25, s[12:15], s57 offen lds
    s_add_u32 m0, s59, 67584
    s_nop 0
    buffer_load_dwordx4 v26, s[12:15], s57 offen lds
    s_add_u32 m0, s59, 68608
    s_nop 0
    buffer_load_dwordx4 v27, s[12:15], s57 offen lds
    s_add_u32 m0, s59, 69632
    s_nop 0
    buffer_load_dwordx4 v28, s[12:15], s57 offen lds
    s_add_u32 m0, s59, 70656
    s_nop 0
    buffer_load_dwordx4 v29, s[12:15], s57 offen lds
    s_add_u32 m0, s100, 90112
    s_nop 0
    buffer_load_dwordx4 v30, s[8:11], s58 offen lds
    s_add_u32 m0, s100, 91136
    s_nop 0
    buffer_load_dwordx4 v31, s[8:11], s58 offen lds
    s_add_u32 s56, s56, 1
    s_cmp_ge_u32 s56, 10
    s_cselect_b32 s56, 0, s56
    s_add_u32 s63, s50, 2048
    buffer_store_dwordx4 v[84:87], v10, s[28:31], s63 offen sc1
    s_waitcnt vmcnt(8)
    s_barrier
    s_mul_i32 s57, s56, 786432
    s_lshl_b32 s58, s56, 7
    s_add_u32 m0, s59, 0
    s_nop 0
    buffer_load_dwordx4 v24, s[12:15], s57 offen lds
    s_add_u32 m0, s59, 1024
    s_nop 0
    buffer_load_dwordx4 v25, s[12:15], s57 offen lds
    s_add_u32 m0, s59, 2048
    s_nop 0
    buffer_load_dwordx4 v26, s[12:15], s57 offen lds
    s_add_u32 m0, s59, 3072
    s_nop 0
    buffer_load_dwordx4 v27, s[12:15], s57 offen lds
    s_add_u32 m0, s59, 4096
    s_nop 0
    buffer_load_dwordx4 v28, s[12:15], s57 offen lds
    s_add_u32 m0, s59, 5120
    s_nop 0
    buffer_load_dwordx4 v29, s[12:15], s57 offen lds
    s_add_u32 m0, s100, 24576
    s_nop 0
    buffer_load_dwordx4 v30, s[8:11], s58 offen lds
    s_add_u32 m0, s100, 25600
    s_nop 0
    buffer_load_dwordx4 v31, s[8:11], s58 offen lds
    s_add_u32 s56, s56, 1
    s_cmp_ge_u32 s56, 10
    s_cselect_b32 s56, 0, s56
    s_add_u32 m0, s59, 131072
    s_nop 0
    buffer_load_dwordx4 v32, s[16:19], 0 offen nt lds
    s_add_u32 m0, s59, 132096
    s_nop 0
    buffer_load_dwordx4 v33, s[16:19], 0 offen nt lds
    s_add_u32 m0, s59, 133120
    s_nop 0
    buffer_load_dwordx4 v34, s[16:19], 0 offen nt lds
    s_add_u32 m0, s59, 134144
    s_nop 0
    buffer_load_dwordx4 v35, s[16:19], 0 offen nt lds
    s_add_u32 m0, s59, 135168
    s_nop 0
    buffer_load_dwordx4 v36, s[16:19], 0 offen nt lds
    s_add_u32 m0, s59, 136192
    s_nop 0
    buffer_load_dwordx4 v37, s[16:19], 0 offen nt lds
    s_add_u32 s62, s61, 0
    s_and_b32 s62, s62, 3
    s_add_u32 s63, s41, 0
    s_cmp_ge_u32 s63, 3
    s_cselect_b32 s46, 3, 0
    s_sub_u32 s63, s63, s46
    s_mul_i32 s40, s62, 245760
    s_mul_i32 s46, s63, 81920
    s_add_u32 s40, s40, s46
    s_mul_i32 s101, s62, 24576
    s_lshl_b32 s46, s63, 7
    s_add_u32 s101, s101, s46
    s_add_u32 m0, s60, 98304
    s_nop 0
    buffer_load_dwordx4 v40, s[24:27], s40 offen lds
    s_add_u32 m0, s60, 99328
    s_nop 0
    buffer_load_dwordx4 v41, s[24:27], s40 offen lds
    s_add_u32 m0, s60, 100352
    s_nop 0
    buffer_load_dwordx4 v42, s[24:27], s40 offen lds
    s_add_u32 m0, s60, 101376
    s_nop 0
    buffer_load_dwordx4 v43, s[24:27], s40 offen lds
    s_add_u32 m0, s60, 102400
    s_nop 0
    buffer_load_dwordx4 v44, s[24:27], s40 offen lds
    s_add_u32 m0, s100, 118784
    s_nop 0
    buffer_load_dwordx4 v45, s[20:23], s101 offen lds
    s_add_u32 m0, s100, 119808
    s_nop 0
    buffer_load_dwordx4 v46, s[20:23], s101 offen lds
    s_add_u32 s63, s50, 3072
    buffer_store_dwordx4 v[84:87], v10, s[28:31], s63 offen sc1
    s_waitcnt vmcnt(21)
    s_barrier
    s_mul_i32 s57, s56, 786432
    s_lshl_b32 s58, s56, 7
    s_add_u32 m0, s59, 32768
    s_nop 0
    buffer_load_dwordx4 v24, s[12:15], s57 offen lds
    s_add_u32 m0, s59, 33792
    s_nop 0
    buffer_load_dwordx4 v25, s[12:15], s57 offen lds
    s_add_u32 m0, s59, 34816
    s_nop 0
    buffer_load_dwordx4 v26, s[12:15], s57 offen lds
    s_add_u32 m0, s59, 35840
    s_nop 0
    buffer_load_dwordx4 v27, s[12:15], s57 offen lds
    s_add_u32 m0, s59, 36864
    s_nop 0
    buffer_load_dwordx4 v28, s[12:15], s57 offen lds
    s_add_u32 m0, s59, 37888
    s_nop 0
    buffer_load_dwordx4 v29, s[12:15], s57 offen lds
    s_add_u32 m0, s100, 57344
    s_nop 0
    buffer_load_dwordx4 v30, s[8:11], s58 offen lds
    s_add_u32 m0, s100, 58368
    s_nop 0
    buffer_load_dwordx4 v31, s[8:11], s58 offen lds
    s_add_u32 s56, s56, 1
    s_cmp_ge_u32 s56, 10
    s_cselect_b32 s56, 0, s56
    s_add_u32 s63, s50, 4096
    buffer_store_dwordx4 v[84:87], v10, s[28:31], s63 offen sc1
    s_waitcnt vmcnt(21)
    s_waitcnt vmcnt(15)
    s_barrier
    s_mul_i32 s57, s56, 786432
    s_lshl_b32 s58, s56, 7
    s_add_u32 m0, s59, 65536
    s_nop 0
    buffer_load_dwordx4 v24, s[12:15], s57 offen lds
    s_add_u32 m0, s59, 66560
    s_nop 0
    buffer_load_dwordx4 v25, s[12:15], s57 offen lds
    s_add_u32 m0, s59, 67584
    s_nop 0
    buffer_load_dwordx4 v26, s[12:15], s57 offen lds
    s_add_u32 m0, s59, 68608
    s_nop 0
    buffer_load_dwordx4 v27, s[12:15], s57 offen lds
    s_add_u32 m0, s59, 69632
    s_nop 0
    buffer_load_dwordx4 v28, s[12:15], s57 offen lds
    s_add_u32 m0, s59, 70656
    s_nop 0
    buffer_load_dwordx4 v29, s[12:15], s57 offen lds
    s_add_u32 m0, s100, 90112
    s_nop 0
    buffer_load_dwordx4 v30, s[8:11], s58 offen lds
    s_add_u32 m0, s100, 91136
    s_nop 0
    buffer_load_dwordx4 v31, s[8:11], s58 offen lds
    s_add_u32 s56, s56, 1
    s_cmp_ge_u32 s56, 10
    s_cselect_b32 s56, 0, s56
    s_waitcnt vmcnt(8)
    s_barrier
    s_mul_i32 s57, s56, 786432
    s_lshl_b32 s58, s56, 7
    s_add_u32 m0, s59, 0
    s_nop 0
    buffer_load_dwordx4 v24, s[12:15], s57 offen lds
    s_add_u32 m0, s59, 1024
    s_nop 0
    buffer_load_dwordx4 v25, s[12:15], s57 offen lds
    s_add_u32 m0, s59, 2048
    s_nop 0
    buffer_load_dwordx4 v26, s[12:15], s57 offen lds
    s_add_u32 m0, s59, 3072
    s_nop 0
    buffer_load_dwordx4 v27, s[12:15], s57 offen lds
    s_add_u32 m0, s59, 4096
    s_nop 0
    buffer_load_dwordx4 v28, s[12:15], s57 offen lds
    s_add_u32 m0, s59, 5120
    s_nop 0
    buffer_load_dwordx4 v29, s[12:15], s57 offen lds
    s_add_u32 m0, s100, 24576
    s_nop 0
    buffer_load_dwordx4 v30, s[8:11], s58 offen lds
    s_add_u32 m0, s100, 25600
    s_nop 0
    buffer_load_dwordx4 v31, s[8:11], s58 offen lds
    s_add_u32 s56, s56, 1
    s_cmp_ge_u32 s56, 10
    s_cselect_b32 s56, 0, s56
    s_waitcnt vmcnt(8)
    s_barrier
    s_add_u32 s62, s61, 0
    s_and_b32 s62, s62, 3
    s_add_u32 s63, s41, 1
    s_cmp_ge_u32 s63, 3
    s_cselect_b32 s46, 3, 0
    s_sub_u32 s63, s63, s46
    s_mul_i32 s40, s62, 245760
    s_mul_i32 s46, s63, 81920
    s_add_u32 s40, s40, s46
    s_mul_i32 s101, s62, 24576
    s_lshl_b32 s46, s63, 7
    s_add_u32 s101, s101, s46
    s_add_u32 m0, s60, 32768
    s_nop 0
    buffer_load_dwordx4 v40, s[24:27], s40 offen lds
    s_add_u32 m0, s60, 33792
    s_nop 0
    buffer_load_dwordx4 v41, s[24:27], s40 offen lds
    s_add_u32 m0, s60, 34816
    s_nop 0
    buffer_load_dwordx4 v42, s[24:27], s40 offen lds
    s_add_u32 m0, s60, 35840
    s_nop 0
    buffer_load_dwordx4 v43, s[24:27], s40 offen lds
    s_add_u32 m0, s60, 36864
    s_nop 0
    buffer_load_dwordx4 v44, s[24:27], s40 offen lds
    s_add_u32 m0, s100, 53248
    s_nop 0
    buffer_load_dwordx4 v45, s[20:23], s101 offen lds
    s_add_u32 m0, s100, 54272
    s_nop 0
    buffer_load_dwordx4 v46, s[20:23], s101 offen lds
    s_add_u32 s62, s61, 0
    s_and_b32 s62, s62, 3
    s_add_u32 s63, s41, 2
    s_cmp_ge_u32 s63, 3
    s_cselect_b32 s46, 3, 0
    s_sub_u32 s63, s63, s46
    s_mul_i32 s40, s62, 245760
    s_mul_i32 s46, s63, 81920
    s_add_u32 s40, s40, s46
    s_mul_i32 s101, s62, 24576
    s_lshl_b32 s46, s63, 7
    s_add_u32 s101, s101, s46
    v_and_b32 v4, 15, v1
    v_add_u32 v4, v4, v3
    v_mul_u32_u24 v4, 384, v4
    buffer_load_dword v82, v4, s[20:23], s101 offen
    s_waitcnt vmcnt(8)
    s_barrier
    s_add_u32 s62, s61, 0
    s_and_b32 s62, s62, 3
    s_add_u32 s63, s41, 2
    s_cmp_ge_u32 s63, 3
    s_cselect_b32 s46, 3, 0
    s_sub_u32 s63, s63, s46
    s_mul_i32 s40, s62, 245760
    s_mul_i32 s46, s63, 81920
    s_add_u32 s40, s40, s46
    s_mul_i32 s101, s62, 24576
    s_lshl_b32 s46, s63, 7
    s_add_u32 s101, s101, s46
    s_add_u32 m0, s60, 65536
    s_nop 0
    buffer_load_dwordx4 v40, s[24:27], s40 offen lds
    s_add_u32 m0, s60, 66560
    s_nop 0
    buffer_load_dwordx4 v41, s[24:27], s40 offen lds
    s_add_u32 m0, s60, 67584
    s_nop 0
    buffer_load_dwordx4 v42, s[24:27], s40 offen lds
    s_add_u32 m0, s60, 68608
    s_nop 0
    buffer_load_dwordx4 v43, s[24:27], s40 offen lds
    s_add_u32 m0, s60, 69632
    s_nop 0
    buffer_load_dwordx4 v44, s[24:27], s40 offen lds
    s_add_u32 m0, s100, 86016
    s_nop 0
    buffer_load_dwordx4 v45, s[20:23], s101 offen lds
    s_add_u32 m0, s100, 87040
    s_nop 0
    buffer_load_dwordx4 v46, s[20:23], s101 offen lds
    s_waitcnt vmcnt(39)
    s_waitcnt vmcnt(31)
    s_barrier
    s_cmp_lg_u32 s98, 0
    s_cbranch_scc1 L_37
    s_lshl_b32 s62, s4, 5
    v_mov_b32 v4, s62
    v_mov_b32 v5, 1
    s_mov_b64 s[62:63], exec
    s_mov_b64 exec, 1
    buffer_atomic_add v5, v4, s[36:39], 0 offen offset:0 sc1
    s_mov_b64 exec, s[62:63]
L_37:
    s_waitcnt vmcnt(8)
    s_barrier
    s_add_u32 s62, s61, 1
    s_and_b32 s62, s62, 3
    s_add_u32 s63, s41, 0
    s_cmp_ge_u32 s63, 3
    s_cselect_b32 s46, 3, 0
    s_sub_u32 s63, s63, s46
    s_mul_i32 s40, s62, 245760
    s_mul_i32 s46, s63, 81920
    s_add_u32 s40, s40, s46
    s_mul_i32 s101, s62, 24576
    s_lshl_b32 s46, s63, 7
    s_add_u32 s101, s101, s46
    s_add_u32 m0, s60, 98304
    s_nop 0
    buffer_load_dwordx4 v40, s[24:27], s40 offen lds
    s_add_u32 m0, s60, 99328
    s_nop 0
    buffer_load_dwordx4 v41, s[24:27], s40 offen lds
    s_add_u32 m0, s60, 100352
    s_nop 0
    buffer_load_dwordx4 v42, s[24:27], s40 offen lds
    s_add_u32 m0, s60, 101376
    s_nop 0
    buffer_load_dwordx4 v43, s[24:27], s40 offen lds
    s_add_u32 m0, s60, 102400
    s_nop 0
    buffer_load_dwordx4 v44, s[24:27], s40 offen lds
    s_add_u32 m0, s100, 118784
    s_nop 0
    buffer_load_dwordx4 v45, s[20:23], s101 offen lds
    s_add_u32 m0, s100, 119808
    s_nop 0
    buffer_load_dwordx4 v46, s[20:23], s101 offen lds
    s_waitcnt vmcnt(7)
    s_barrier
    s_add_u32 s62, s61, 1
    s_and_b32 s62, s62, 3
    s_add_u32 s63, s41, 1
    s_cmp_ge_u32 s63, 3
    s_cselect_b32 s46, 3, 0
    s_sub_u32 s63, s63, s46
    s_mul_i32 s40, s62, 245760
    s_mul_i32 s46, s63, 81920
    s_add_u32 s40, s40, s46
    s_mul_i32 s101, s62, 24576
    s_lshl_b32 s46, s63, 7
    s_add_u32 s101, s101, s46
    s_add_u32 m0, s60, 0
    s_nop 0
    buffer_load_dwordx4 v40, s[24:27], s40 offen lds
    s_add_u32 m0, s60, 1024
    s_nop 0
    buffer_load_dwordx4 v41, s[24:27], s40 offen lds
    s_add_u32 m0, s60, 2048
    s_nop 0
    buffer_load_dwordx4 v42, s[24:27], s40 offen lds
    s_add_u32 m0, s60, 3072
    s_nop 0
    buffer_load_dwordx4 v43, s[24:27], s40 offen lds
    s_add_u32 m0, s60, 4096
    s_nop 0
    buffer_load_dwordx4 v44, s[24:27], s40 offen lds
    s_add_u32 m0, s100, 20480
    s_nop 0
    buffer_load_dwordx4 v45, s[20:23], s101 offen lds
    s_add_u32 m0, s100, 21504
    s_nop 0
    buffer_load_dwordx4 v46, s[20:23], s101 offen lds
    s_add_u32 s62, s61, 1
    s_and_b32 s62, s62, 3
    s_add_u32 s63, s41, 2
    s_cmp_ge_u32 s63, 3
    s_cselect_b32 s46, 3, 0
    s_sub_u32 s63, s63, s46
    s_mul_i32 s40, s62, 245760
    s_mul_i32 s46, s63, 81920
    s_add_u32 s40, s40, s46
    s_mul_i32 s101, s62, 24576
    s_lshl_b32 s46, s63, 7
    s_add_u32 s101, s101, s46
    s_add_u32 m0, s60, 131072
    s_nop 0
    buffer_load_dwordx4 v40, s[24:27], s40 offen lds
    s_add_u32 m0, s60, 132096
    s_nop 0
    buffer_load_dwordx4 v41, s[24:27], s40 offen lds
    s_add_u32 m0, s60, 133120
    s_nop 0
    buffer_load_dwordx4 v42, s[24:27], s40 offen lds
    s_add_u32 m0, s60, 134144
    s_nop 0
    buffer_load_dwordx4 v43, s[24:27], s40 offen lds
    s_add_u32 m0, s60, 135168
    s_nop 0
    buffer_load_dwordx4 v44, s[24:27], s40 offen lds
    s_add_u32 m0, s100, 151552
    s_nop 0
    buffer_load_dwordx4 v45, s[20:23], s101 offen lds
    s_add_u32 m0, s100, 152576
    s_nop 0
    buffer_load_dwordx4 v46, s[20:23], s101 offen lds
    s_waitcnt vmcnt(14)
    s_barrier
    s_add_u32 s62, s61, 2
    s_and_b32 s62, s62, 3
    s_add_u32 s63, s41, 0
    s_cmp_ge_u32 s63, 3
    s_cselect_b32 s46, 3, 0
    s_sub_u32 s63, s63, s46
    s_mul_i32 s40, s62, 245760
    s_mul_i32 s46, s63, 81920
    s_add_u32 s40, s40, s46
    s_mul_i32 s101, s62, 24576
    s_lshl_b32 s46, s63, 7
    s_add_u32 s101, s101, s46
    s_add_u32 m0, s60, 32768
    s_nop 0
    buffer_load_dwordx4 v40, s[24:27], s40 offen lds
    s_add_u32 m0, s60, 33792
    s_nop 0
    buffer_load_dwordx4 v41, s[24:27], s40 offen lds
    s_add_u32 m0, s60, 34816
    s_nop 0
    buffer_load_dwordx4 v42, s[24:27], s40 offen lds
    s_add_u32 m0, s60, 35840
    s_nop 0
    buffer_load_dwordx4 v43, s[24:27], s40 offen lds
    s_add_u32 m0, s60, 36864
    s_nop 0
    buffer_load_dwordx4 v44, s[24:27], s40 offen lds
    s_add_u32 m0, s100, 53248
    s_nop 0
    buffer_load_dwordx4 v45, s[20:23], s101 offen lds
    s_add_u32 m0, s100, 54272
    s_nop 0
    buffer_load_dwordx4 v46, s[20:23], s101 offen lds
    s_waitcnt vmcnt(14)
    s_barrier
    s_add_u32 s62, s61, 2
    s_and_b32 s62, s62, 3
    s_add_u32 s63, s41, 1
    s_cmp_ge_u32 s63, 3
    s_cselect_b32 s46, 3, 0
    s_sub_u32 s63, s63, s46
    s_mul_i32 s40, s62, 245760
    s_mul_i32 s46, s63, 81920
    s_add_u32 s40, s40, s46
    s_mul_i32 s101, s62, 24576
    s_lshl_b32 s46, s63, 7
    s_add_u32 s101, s101, s46
    s_add_u32 m0, s60, 65536
    s_nop 0
    buffer_load_dwordx4 v40, s[24:27], s40 offen lds
    s_add_u32 m0, s60, 66560
    s_nop 0
    buffer_load_dwordx4 v41, s[24:27], s40 offen lds
    s_add_u32 m0, s60, 67584
    s_nop 0
    buffer_load_dwordx4 v42, s[24:27], s40 offen lds
    s_add_u32 m0, s60, 68608
    s_nop 0
    buffer_load_dwordx4 v43, s[24:27], s40 offen lds
    s_add_u32 m0, s60, 69632
    s_nop 0
    buffer_load_dwordx4 v44, s[24:27], s40 offen lds
    s_add_u32 m0, s100, 86016
    s_nop 0
    buffer_load_dwordx4 v45, s[20:23], s101 offen lds
    s_add_u32 m0, s100, 87040
    s_nop 0
    buffer_load_dwordx4 v46, s[20:23], s101 offen lds
    s_waitcnt vmcnt(14)
    s_barrier
    s_cmp_lg_u32 s98, 0
    s_cbranch_scc1 L_38
    s_lshl_b32 s62, s4, 5
    v_mov_b32 v16, s62
    buffer_load_dword v15, v16, s[36:39], 0 offen offset:0 sc1
L_38:
    s_add_u32 s62, s61, 2
    s_and_b32 s62, s62, 3
    s_add_u32 s63, s41, 2
    s_cmp_ge_u32 s63, 3
    s_cselect_b32 s46, 3, 0
    s_sub_u32 s63, s63, s46
    s_mul_i32 s40, s62, 245760
    s_mul_i32 s46, s63, 81920
    s_add_u32 s40, s40, s46
    s_mul_i32 s101, s62, 24576
    s_lshl_b32 s46, s63, 7
    s_add_u32 s101, s101, s46
    s_add_u32 m0, s60, 98304
    s_nop 0
    buffer_load_dwordx4 v40, s[24:27], s40 offen lds
    s_add_u32 m0, s60, 99328
    s_nop 0
    buffer_load_dwordx4 v41, s[24:27], s40 offen lds
    s_add_u32 m0, s60, 100352
    s_nop 0
    buffer_load_dwordx4 v42, s[24:27], s40 offen lds
    s_add_u32 m0, s60, 101376
    s_nop 0
    buffer_load_dwordx4 v43, s[24:27], s40 offen lds
    s_add_u32 m0, s60, 102400
    s_nop 0
    buffer_load_dwordx4 v44, s[24:27], s40 offen lds
    s_add_u32 m0, s100, 118784
    s_nop 0
    buffer_load_dwordx4 v45, s[20:23], s101 offen lds
    s_add_u32 m0, s100, 119808
    s_nop 0
    buffer_load_dwordx4 v46, s[20:23], s101 offen lds
    s_waitcnt vmcnt(14)
    s_barrier
    s_cmp_lg_u32 s98, 0
    s_cbranch_scc1 L_39
    s_waitcnt vmcnt(7)
    s_mov_b32 s48, 0
L_40:
    v_readfirstlane_b32 s62, v15
    s_cmp_ge_u32 s62, 32
    s_cbranch_scc1 L_41
    s_add_u32 s48, s48, 1
    s_cmp_gt_u32 s48, 200000
    s_cbranch_scc1 L_41
    s_sleep 2
    buffer_load_dword v15, v16, s[36:39], 0 offen offset:0 sc1
    s_waitcnt vmcnt(0)
    s_branch L_40
L_41:
L_39:
    s_add_u32 s62, s61, 3
    s_and_b32 s62, s62, 3
    s_add_u32 s63, s41, 0
    s_cmp_ge_u32 s63, 3
    s_cselect_b32 s46, 3, 0
    s_sub_u32 s63, s63, s46
    s_mul_i32 s40, s62, 245760
    s_mul_i32 s46, s63, 81920
    s_add_u32 s40, s40, s46
    s_mul_i32 s101, s62, 24576
    s_lshl_b32 s46, s63, 7
    s_add_u32 s101, s101, s46
    s_add_u32 m0, s60, 0
    s_nop 0
    buffer_load_dwordx4 v40, s[24:27], s40 offen lds
    s_add_u32 m0, s60, 1024
    s_nop 0
    buffer_load_dwordx4 v41, s[24:27], s40 offen lds
    s_add_u32 m0, s60, 2048
    s_nop 0
    buffer_load_dwordx4 v42, s[24:27], s40 offen lds
    s_add_u32 m0, s60, 3072
    s_nop 0
    buffer_load_dwordx4 v43, s[24:27], s40 offen lds
    s_add_u32 m0, s60, 4096
    s_nop 0
    buffer_load_dwordx4 v44, s[24:27], s40 offen lds
    s_add_u32 m0, s100, 20480
    s_nop 0
    buffer_load_dwordx4 v45, s[20:23], s101 offen lds
    s_add_u32 m0, s100, 21504
    s_nop 0
    buffer_load_dwordx4 v46, s[20:23], s101 offen lds
    s_waitcnt vmcnt(14)
    s_barrier
    s_add_u32 s62, s61, s98
    s_and_b32 s62, s62, 3
    s_lshl_b32 s62, s62, 7
    s_add_u32 s56, s62, s43
    v_lshlrev_b32 v18, 2, v1
    buffer_load_dword v17, v18, s[28:31], s56 offen sc1
    s_add_u32 s62, s61, 3
    s_and_b32 s62, s62, 3
    s_add_u32 s63, s41, 1
    s_cmp_ge_u32 s63, 3
    s_cselect_b32 s46, 3, 0
    s_sub_u32 s63, s63, s46
    s_mul_i32 s40, s62, 245760
    s_mul_i32 s46, s63, 81920
    s_add_u32 s40, s40, s46
    s_mul_i32 s101, s62, 24576
    s_lshl_b32 s46, s63, 7
    s_add_u32 s101, s101, s46
    s_add_u32 m0, s60, 131072
    s_nop 0
    buffer_load_dwordx4 v40, s[24:27], s40 offen lds
    s_add_u32 m0, s60, 132096
    s_nop 0
    buffer_load_dwordx4 v41, s[24:27], s40 offen lds
    s_add_u32 m0, s60, 133120
    s_nop 0
    buffer_load_dwordx4 v42, s[24:27], s40 offen lds
    s_add_u32 m0, s60, 134144
    s_nop 0
    buffer_load_dwordx4 v43, s[24:27], s40 offen lds
    s_add_u32 m0, s60, 135168
    s_nop 0
    buffer_load_dwordx4 v44, s[24:27], s40 offen lds
    s_add_u32 m0, s100, 151552
    s_nop 0
    buffer_load_dwordx4 v45, s[20:23], s101 offen lds
    s_add_u32 m0, s100, 152576
    s_nop 0
    buffer_load_dwordx4 v46, s[20:23], s101 offen lds
    s_waitcnt vmcnt(15)
    s_barrier
    s_add_u32 s62, s61, 3
    s_and_b32 s62, s62, 3
    s_add_u32 s63, s41, 2
    s_cmp_ge_u32 s63, 3
    s_cselect_b32 s46, 3, 0
    s_sub_u32 s63, s63, s46
    s_mul_i32 s40, s62, 245760
    s_mul_i32 s46, s63, 81920
    s_add_u32 s40, s40, s46
    s_mul_i32 s101, s62, 24576
    s_lshl_b32 s46, s63, 7
    s_add_u32 s101, s101, s46
    s_add_u32 m0, s60, 32768
    s_nop 0
    buffer_load_dwordx4 v40, s[24:27], s40 offen lds
    s_add_u32 m0, s60, 33792
    s_nop 0
    buffer_load_dwordx4 v41, s[24:27], s40 offen lds
    s_add_u32 m0, s60, 34816
    s_nop 0
    buffer_load_dwordx4 v42, s[24:27], s40 offen lds
    s_add_u32 m0, s60, 35840
    s_nop 0
    buffer_load_dwordx4 v43, s[24:27], s40 offen lds
    s_add_u32 m0, s60, 36864
    s_nop 0
    buffer_load_dwordx4 v44, s[24:27], s40 offen lds
    s_add_u32 m0, s100, 53248
    s_nop 0
    buffer_load_dwordx4 v45, s[20:23], s101 offen lds
    s_add_u32 m0, s100, 54272
    s_nop 0
    buffer_load_dwordx4 v46, s[20:23], s101 offen lds
    s_waitcnt vmcnt(15)
    s_barrier
    s_waitcnt vmcnt(14)
    s_mov_b32 s48, 0
    s_mov_b64 s[62:63], exec
    s_mov_b64 exec, 0xf
L_42:
    v_cmp_ne_u32 vcc, 1, v17
    s_cbranch_vccz L_43
    s_add_u32 s48, s48, 1
    s_cmp_gt_u32 s48, 200000
    s_cbranch_scc1 L_43
    buffer_load_dword v17, v18, s[28:31], s56 offen sc1
    s_waitcnt vmcnt(0)
    s_branch L_42
L_43:
    s_mov_b64 exec, s[62:63]
    s_lshl_b32 s62, s4, 5
    s_lshl_b32 s63, s5, 2
    s_add_u32 s47, s62, s63
    s_add_u32 s62, s61, s98
    s_and_b32 s62, s62, 3
    s_add_u32 s62, s62, s47
    s_lshl_b32 s62, s62, 13
    buffer_load_dwordx4 v[48:51], v10, s[28:31], s62 offen offset:0 sc1
    buffer_load_dwordx4 v[52:55], v10, s[28:31], s62 offen offset:1024 sc1
    buffer_load_dwordx4 v[56:59], v10, s[28:31], s62 offen offset:2048 sc1
    buffer_load_dwordx4 v[60:63], v10, s[28:31], s62 offen offset:3072 sc1
    s_add_u32 s62, s62, 4096
    buffer_load_dwordx4 v[64:67], v10, s[28:31], s62 offen offset:0 sc1
    buffer_load_dwordx4 v[68:71], v10, s[28:31], s62 offen offset:1024 sc1
    buffer_load_dwordx4 v[72:75], v10, s[28:31], s62 offen offset:2048 sc1
    buffer_load_dwordx4 v[76:79], v10, s[28:31], s62 offen offset:3072 sc1
    s_waitcnt vmcnt(15)
    s_barrier
    s_waitcnt vmcnt(8)
    s_barrier
    s_waitcnt vmcnt(0)
    s_lshl_b32 s62, s98, 13
    s_add_u32 s62, s62, 65536
    v_add_u32 v16, s62, v10
    ds_write_b128 v16, v[48:51] offset:0
    ds_write_b128 v16, v[52:55] offset:1024
    ds_write_b128 v16, v[56:59] offset:2048
    ds_write_b128 v16, v[60:63] offset:3072
    ds_write_b128 v16, v[64:67] offset:4096
    ds_write_b128 v16, v[68:71] offset:5120
    ds_write_b128 v16, v[72:75] offset:6144
    ds_write_b128 v16, v[76:79] offset:7168
    s_waitcnt lgkmcnt(0)
    s_barrier
    s_barrier
    s_cmp_lg_u32 s3, 4
    s_cbranch_scc1 L_44
    s_mov_b32 s56, 4
    v_mul_u32_u24 v22, 1280, v12
    v_lshl_add_u32 v22, v13, 3, v22
    s_lshl_b32 s62, s56, 9
    s_add_u32 s47, s51, s62
    s_mov_b32 s48, 0
L_45:
    s_add_u32 s62, s47, 0
    buffer_load_dwordx2 v[48:49], v11, s[28:31], s62 offen sc1
    s_add_u32 s62, s47, 20480
    buffer_load_dwordx2 v[50:51], v11, s[28:31], s62 offen sc1
    s_add_u32 s62, s47, 40960
    buffer_load_dwordx2 v[52:53], v11, s[28:31], s62 offen sc1
    s_add_u32 s62, s47, 61440
    buffer_load_dwordx2 v[54:55], v11, s[28:31], s62 offen sc1
    s_add_u32 s62, s47, 81920
    buffer_load_dwordx2 v[56:57], v11, s[28:31], s62 offen sc1
    s_add_u32 s62, s47, 102400
    buffer_load_dwordx2 v[58:59], v11, s[28:31], s62 offen sc1
    s_add_u32 s62, s47, 122880
    buffer_load_dwordx2 v[60:61], v11, s[28:31], s62 offen sc1
    s_add_u32 s62, s47, 143360
    buffer_load_dwordx2 v[62:63], v11, s[28:31], s62 offen sc1
    s_waitcnt vmcnt(0)
    v_max3_u32 v14, v48, v49, v50
    v_max3_u32 v14, v14, v51, v52
    v_max3_u32 v14, v14, v53, v54
    v_max3_u32 v14, v14, v55, v56
    v_max3_u32 v14, v14, v57, v58
    v_max3_u32 v14, v14, v59, v60
    v_max3_u32 v14, v14, v61, v62
    v_max_u32 v14, v14, v63
    v_cmp_eq_u32 vcc, -1, v14
    s_cbranch_vccz L_46
    s_add_u32 s48, s48, 1
    s_cmp_gt_u32 s48, 200000
    s_cbranch_scc0 L_45
L_46:
    v_lshlrev_b32 v16, 16, v48
    v_and_b32 v17, 0xffff0000, v48
    v_lshlrev_b32 v18, 16, v49
    v_and_b32 v19, 0xffff0000, v49
    v_lshlrev_b32 v20, 16, v50
    v_and_b32 v21, 0xffff0000, v50
    v_add_f32 v16, v16, v20
    v_add_f32 v17, v17, v21
    v_lshlrev_b32 v20, 16, v51
    v_and_b32 v21, 0xffff0000, v51
    v_add_f32 v18, v18, v20
    v_add_f32 v19, v19, v21
    v_lshlrev_b32 v20, 16, v52
    v_and_b32 v21, 0xffff0000, v52
    v_add_f32 v16, v16, v20
    v_add_f32 v17, v17, v21
    v_lshlrev_b32 v20, 16, v53
    v_and_b32 v21, 0xffff0000, v53
    v_add_f32 v18, v18, v20
    v_add_f32 v19, v19, v21
    v_lshlrev_b32 v20, 16, v54
    v_and_b32 v21, 0xffff0000, v54
    v_add_f32 v16, v16, v20
    v_add_f32 v17, v17, v21
    v_lshlrev_b32 v20, 16, v55
    v_and_b32 v21, 0xffff0000, v55
    v_add_f32 v18, v18, v20
    v_add_f32 v19, v19, v21
    v_lshlrev_b32 v20, 16, v56
    v_and_b32 v21, 0xffff0000, v56
    v_add_f32 v16, v16, v20
    v_add_f32 v17, v17, v21
    v_lshlrev_b32 v20, 16, v57
    v_and_b32 v21, 0xffff0000, v57
    v_add_f32 v18, v18, v20
    v_add_f32 v19, v19, v21
    v_lshlrev_b32 v20, 16, v58
    v_and_b32 v21, 0xffff0000, v58
    v_add_f32 v16, v16, v20
    v_add_f32 v17, v17, v21
    v_lshlrev_b32 v20, 16, v59
    v_and_b32 v21, 0xffff0000, v59
    v_add_f32 v18, v18, v20
    v_add_f32 v19, v19, v21
    v_lshlrev_b32 v20, 16, v60
    v_and_b32 v21, 0xffff0000, v60
    v_add_f32 v16, v16, v20
    v_add_f32 v17, v17, v21
    v_lshlrev_b32 v20, 16, v61
    v_and_b32 v21, 0xffff0000, v61
    v_add_f32 v18, v18, v20
    v_add_f32 v19, v19, v21
    v_lshlrev_b32 v20, 16, v62
    v_and_b32 v21, 0xffff0000, v62
    v_add_f32 v16, v16, v20
    v_add_f32 v17, v17, v21
    v_lshlrev_b32 v20, 16, v63
    v_and_b32 v21, 0xffff0000, v63
    v_add_f32 v18, v18, v20
    v_add_f32 v19, v19, v21
    v_cvt_pk_bf16_f32 v20, v16, v17
    v_cvt_pk_bf16_f32 v21, v18, v19
    s_lshl_b32 s62, s56, 5
    s_add_u32 s62, s62, s52
    buffer_store_dwordx2 v[20:21], v22, s[32:35], s62 offen
L_44:
L_end:
    s_endpgm
.section .rodata,"a"
.p2align 6
.amdhsa_kernel standalone__mha_block_cached__near_ridge_kernel
  .amdhsa_next_free_vgpr 256
  .amdhsa_next_free_sgpr 102
  .amdhsa_accum_offset 120
  .amdhsa_group_segment_fixed_size 0
  .amdhsa_kernarg_size 64
  .amdhsa_user_sgpr_count 2
  .amdhsa_user_sgpr_kernarg_segment_ptr 1
  .amdhsa_system_sgpr_workgroup_id_x 1
.end_amdhsa_kernel
```
